```python
import torch

def _softmax(x, axis=-1):
    return torch.softmax(x, dim=axis)
def _gelu(x):
    return torch.nn.functional.gelu(x, approximate="tanh")
def _silu(x):
    return torch.nn.functional.silu(x)
def _sigmoid(x):
    return torch.sigmoid(x)
def _layernorm(x, axis=-1, eps=1e-5):
    m = x.mean(dim=axis, keepdim=True)
    v = x.var(dim=axis, keepdim=True, unbiased=False)
    return (x - m) / torch.sqrt(v + eps)
def _scatter_add(tgt, idx, src, axis=0):
    return tgt.clone().index_add_(axis, idx, src)
def _segment_sum(src, seg, n):
    out = torch.zeros((n,) + src.shape[1:], dtype=src.dtype)
    return out.index_add_(0, seg, src)
def _pad(x, pw):
    flat = tuple(v for pair in reversed(pw) for v in pair)
    return torch.nn.functional.pad(x, flat)

kernel_name = 'standalone__mha_block_cached__near_ridge'

def setup_inputs():

    _w = (lambda a: (lambda t: t.to(torch.bfloat16) if t.is_floating_point() else t)(torch.as_tensor(a)))
    B, Sq, D = 16, 112, 576
    H, Sk, Dh = 32, 1024, 128
    return {
        "x": _w((lambda *s: torch.randn(*s, dtype=torch.bfloat16) * 0.8)(B, Sq, D)),
        "k_cache": _w((lambda *s: torch.randn(*s, dtype=torch.bfloat16) * 0.8)(B, H, Sk, Dh)),
        "v_cache": _w((lambda *s: torch.randn(*s, dtype=torch.bfloat16) * 0.05)(B, H, Sk, Dh)),
        "wq": _w((lambda *s: torch.randn(*s, dtype=torch.bfloat16) * 0.8)(D, H * Dh) * (D ** -0.5)),
        "wo": _w((lambda *s: torch.randn(*s, dtype=torch.bfloat16) * 0.05)(H * Dh, D) * ((H * Dh) ** -0.5)),
    }

def reference(x, k_cache, v_cache, wq, wo):
    B, Sq, D = x.shape
    H, Dh = 32, 128
    q = (lambda x, *d: x.permute(*d))((x @ wq).reshape(B, Sq, H, Dh), 0, 2, 1, 3)
    scores = torch.einsum("bhqd,bhkd->bhqk", q, k_cache) * (Dh ** -0.5)
    p = _softmax(scores, axis=-1)
    o = torch.einsum("bhqk,bhkd->bhqd", p, v_cache)
    return (lambda x, *d: x.permute(*d))(o, 0, 2, 1, 3).reshape(B, Sq, H * Dh) @ wo
```

```asm
; @launch kernel=standalone__mha_block_cached__near_ridge_kernel grid=(512,1,1) block=(256,1,1) lds=81920
; @launch kernel=oproj_kernel grid=(256,1,1) block=(512,1,1) lds=131072
.amdgcn_target "amdgcn-amd-amdhsa--gfx950"
.text
.globl standalone__mha_block_cached__near_ridge_kernel
.p2align 8
.type standalone__mha_block_cached__near_ridge_kernel,@function
standalone__mha_block_cached__near_ridge_kernel:
    s_cmp_ge_u32 s2, 512
    s_cbranch_scc1 K1_END
    s_load_dwordx4 s[36:39], s[0:1], 0
    s_load_dwordx4 s[40:43], s[0:1], 16
    s_load_dwordx2 s[44:45], s[0:1], 56
    s_and_b32 s3, s2, 7
    s_lshr_b32 s4, s2, 3
    s_and_b32 s5, s4, 7
    s_lshr_b32 s4, s4, 3
    s_lshl_b32 s5, s5, 3
    s_or_b32 s4, s4, s5
    s_and_b32 s5, s3, 1
    s_lshl_b32 s5, s5, 3
    s_and_b32 s6, s4, 7
    s_add_u32 s5, s5, s6
    s_lshr_b32 s6, s3, 1
    s_lshl_b32 s6, s6, 3
    s_lshr_b32 s7, s4, 3
    s_add_u32 s6, s6, s7
    s_and_b32 s46, s4, 7
    s_lshl_b32 s46, s46, 1
    s_add_u32 s46, s46, s7
    s_cmp_ge_u32 s46, 9
    s_cselect_b32 s47, 9, 0
    s_sub_u32 s46, s46, s47
    s_cmp_ge_u32 s46, 9
    s_cselect_b32 s47, 9, 0
    s_sub_u32 s46, s46, s47
    s_setprio 3
    v_lshrrev_b32 v28, 6, v0
    v_and_b32 v0, 63, v0
    v_readfirstlane_b32 s7, v28
    s_mov_b32 s28, 0x3e0293ee
    s_mov_b32 s29, 0x427af233
    s_lshl_b32 s30, s7, 12
    v_lshrrev_b32 v29, 4, v0
    v_and_b32 v30, 15, v0
    v_lshlrev_b32 v31, 2, v29
    v_xor_b32 v31, v31, v30
    v_lshlrev_b32 v31, 4, v31
    v_lshl_add_u32 v28, v28, 4, v29
    v_lshl_add_u32 v6, v28, 13, v31
    v_lshl_add_u32 v5, v28, 8, v31
    v_add_u32 v31, 0, v29
    v_xor_b32 v31, v31, v30
    v_lshlrev_b32 v31, 4, v31
    v_lshl_add_u32 v1, v28, 8, v31
    v_add_u32 v31, 4, v29
    v_xor_b32 v31, v31, v30
    v_lshlrev_b32 v31, 4, v31
    v_lshl_add_u32 v2, v28, 8, v31
    v_add_u32 v31, 8, v29
    v_xor_b32 v31, v31, v30
    v_lshlrev_b32 v31, 4, v31
    v_lshl_add_u32 v3, v28, 8, v31
    v_add_u32 v31, 12, v29
    v_xor_b32 v31, v31, v30
    v_lshlrev_b32 v31, 4, v31
    v_lshl_add_u32 v4, v28, 8, v31
    v_and_b32 v28, 31, v0
    v_lshrrev_b32 v31, 5, v0
    s_lshl_b32 s34, s7, 5
    v_add_u32 v23, s34, v28
    v_lshrrev_b32 v24, 3, v0
    v_add_u32 v24, s34, v24
    v_and_b32 v25, 7, v0
    v_xor_b32 v25, v25, v29
    v_mul_u32_u24 v24, 1152, v24
    v_lshl_add_u32 v240, v25, 4, v24
    v_xor_b32 v25, 4, v25
    v_lshl_add_u32 v241, v25, 4, v24
    v_add_u32 v242, 16384, v240
    v_add_u32 v243, 24576, v241
    v_add_u32 v241, 8192, v241
    v_mul_u32_u24 v27, 28672, v31
    v_lshl_add_u32 v27, v23, 4, v27
    v_cmp_gt_u32 vcc, 112, v23
    v_mov_b32 v24, 0x7ffffff0
    s_nop 0
    v_cndmask_b32 v27, v24, v27, vcc
    s_waitcnt lgkmcnt(0)
    s_mul_i32 s34, s5, 129024
    s_add_u32 s36, s36, s34
    s_addc_u32 s37, s37, 0
    s_lshl_b32 s34, s5, 5
    s_add_u32 s34, s34, s6
    s_lshl_b32 s34, s34, 18
    s_add_u32 s38, s38, s34
    s_addc_u32 s39, s39, 0
    s_add_u32 s40, s40, s34
    s_addc_u32 s41, s41, 0
    s_lshl_b32 s34, s6, 8
    s_add_u32 s42, s42, s34
    s_addc_u32 s43, s43, 0
    s_mul_i32 s34, s6, 458752
    s_mul_i32 s35, s5, 1792
    s_add_u32 s34, s34, s35
    s_add_u32 s44, s44, s34
    s_addc_u32 s45, s45, 0
    s_mov_b32 s8, s36
    s_mov_b32 s9, s37
    s_mov_b32 s10, 129024
    s_mov_b32 s11, 0x00020000
    s_mov_b32 s12, s38
    s_mov_b32 s13, s39
    s_mov_b32 s14, 262144
    s_mov_b32 s15, 0x00020000
    s_mov_b32 s16, s40
    s_mov_b32 s17, s41
    s_mov_b32 s18, 262144
    s_mov_b32 s19, 0x00020000
    s_mov_b32 s20, s42
    s_mov_b32 s21, s43
    s_mov_b32 s22, 4710656
    s_mov_b32 s23, 0x00020000
    s_mov_b32 s24, s44
    s_mov_b32 s25, s45
    s_mov_b32 s26, 431872
    s_mov_b32 s27, 0x00020000
    s_add_u32 m0, s30, 16384
    s_lshl_b32 s34, s46, 19
    buffer_load_dwordx4 v6, s[20:23], s34 offen offset:0 lds
    s_add_u32 s34, s34, 31744
    buffer_load_dwordx4 v6, s[20:23], s34 offen offset:1024 lds
    s_add_u32 s34, s34, 31744
    buffer_load_dwordx4 v6, s[20:23], s34 offen offset:2048 lds
    s_add_u32 s34, s34, 31744
    buffer_load_dwordx4 v6, s[20:23], s34 offen offset:3072 lds
    s_add_u32 m0, s30, 65536
    s_lshl_b32 s34, s46, 7
    buffer_load_dwordx4 v240, s[8:11], s34 offen offset:0 lds
    buffer_load_dwordx4 v241, s[8:11], s34 offen offset:1024 lds
    buffer_load_dwordx4 v242, s[8:11], s34 offen offset:2048 lds
    buffer_load_dwordx4 v243, s[8:11], s34 offen offset:3072 lds
    s_add_u32 s46, s46, 1
    s_cmp_eq_u32 s46, 9
    s_cselect_b32 s46, 0, s46
    s_add_u32 m0, s30, 49152
    s_lshl_b32 s34, s46, 19
    buffer_load_dwordx4 v6, s[20:23], s34 offen offset:0 lds
    s_add_u32 s34, s34, 31744
    buffer_load_dwordx4 v6, s[20:23], s34 offen offset:1024 lds
    s_add_u32 s34, s34, 31744
    buffer_load_dwordx4 v6, s[20:23], s34 offen offset:2048 lds
    s_add_u32 s34, s34, 31744
    buffer_load_dwordx4 v6, s[20:23], s34 offen offset:3072 lds
    s_add_u32 m0, s30, 32768
    s_lshl_b32 s34, s46, 7
    buffer_load_dwordx4 v240, s[8:11], s34 offen offset:0 lds
    buffer_load_dwordx4 v241, s[8:11], s34 offen offset:1024 lds
    buffer_load_dwordx4 v242, s[8:11], s34 offen offset:2048 lds
    buffer_load_dwordx4 v243, s[8:11], s34 offen offset:3072 lds
    s_add_u32 s46, s46, 1
    s_cmp_eq_u32 s46, 9
    s_cselect_b32 s46, 0, s46
    v_bfe_u32 v23, v28, 1, 3
    v_xor_b32 v23, v23, v31
    v_lshlrev_b32 v24, 7, v28
    v_add_u32 v24, s30, v24
    v_add_u32 v24, 0x8000, v24
    v_xor_b32 v25, 0, v23
    v_lshl_add_u32 v244, v25, 4, v24
    v_xor_b32 v25, 2, v23
    v_lshl_add_u32 v245, v25, 4, v24
    v_xor_b32 v25, 4, v23
    v_lshl_add_u32 v246, v25, 4, v24
    v_xor_b32 v25, 6, v23
    v_lshl_add_u32 v247, v25, 4, v24
    s_mov_b32 s31, 0
    s_mov_b32 s32, 0
    v_lshlrev_b32 v7, 4, v0
    v_add_u32 v7, s30, v7
    s_mul_i32 s31, s5, 1
    s_mul_i32 s32, s6, 1
    s_add_u32 s31, s31, s32
    s_and_b32 s31, s31, 15
    s_lshl_b32 s31, s31, 14
    s_mov_b32 s32, s31
    v_and_b32 v23, 0x13, v28
    v_bfe_u32 v24, v28, 2, 1
    v_lshl_or_b32 v23, v24, 3, v23
    v_bfe_u32 v24, v28, 3, 1
    v_lshl_or_b32 v23, v24, 2, v23
    v_and_b32 v24, 15, v23
    v_xor_b32 v24, v24, v31
    v_xor_b32 v25, 0, v24
    v_lshlrev_b32 v25, 4, v25
    v_lshl_add_u32 v8, v23, 8, v25
    v_xor_b32 v25, 2, v24
    v_lshlrev_b32 v25, 4, v25
    v_lshl_add_u32 v9, v23, 8, v25
    v_xor_b32 v25, 4, v24
    v_lshlrev_b32 v25, 4, v25
    v_lshl_add_u32 v10, v23, 8, v25
    v_xor_b32 v25, 6, v24
    v_lshlrev_b32 v25, 4, v25
    v_lshl_add_u32 v11, v23, 8, v25
    v_xor_b32 v25, 8, v24
    v_lshlrev_b32 v25, 4, v25
    v_lshl_add_u32 v12, v23, 8, v25
    v_xor_b32 v25, 10, v24
    v_lshlrev_b32 v25, 4, v25
    v_lshl_add_u32 v13, v23, 8, v25
    v_xor_b32 v25, 12, v24
    v_lshlrev_b32 v25, 4, v25
    v_lshl_add_u32 v14, v23, 8, v25
    v_xor_b32 v25, 14, v24
    v_lshlrev_b32 v25, 4, v25
    v_lshl_add_u32 v15, v23, 8, v25
    v_lshrrev_b32 v23, 2, v30
    v_and_b32 v24, 1, v0
    v_bfe_u32 v25, v0, 1, 1
    v_lshl_or_b32 v24, v24, 1, v25
    v_lshlrev_b32 v24, 3, v24
    v_and_b32 v25, 1, v29
    v_lshl_or_b32 v24, v25, 5, v24
    v_lshl_add_u32 v25, v31, 3, v23
    v_lshl_add_u32 v24, v25, 8, v24
    v_xor_b32 v25, 0, v23
    v_lshl_add_u32 v16, v25, 6, v24
    v_xor_b32 v25, 1, v23
    v_lshl_add_u32 v17, v25, 6, v24
    v_xor_b32 v25, 2, v23
    v_lshl_add_u32 v18, v25, 6, v24
    v_xor_b32 v25, 3, v23
    v_lshl_add_u32 v19, v25, 6, v24
    s_waitcnt vmcnt(8)
    s_barrier
    ds_read_b128 v[128:131], v244 offset:32768
    ds_read_b128 v[132:135], v245 offset:32768
    ds_read_b128 v[136:139], v246 offset:32768
    ds_read_b128 v[140:143], v247 offset:32768
    ds_read_b64_tr_b16 v[176:177], v16 offset:16384
    ds_read_b64_tr_b16 v[178:179], v16 offset:17408
    ds_read_b64_tr_b16 v[180:181], v17 offset:16384
    ds_read_b64_tr_b16 v[182:183], v17 offset:17408
    ds_read_b64_tr_b16 v[184:185], v18 offset:16384
    ds_read_b64_tr_b16 v[186:187], v18 offset:17408
    ds_read_b64_tr_b16 v[188:189], v19 offset:16384
    ds_read_b64_tr_b16 v[190:191], v19 offset:17408
    s_nop 0
    ds_read_b64_tr_b16 v[192:193], v16 offset:20480
    ds_read_b64_tr_b16 v[194:195], v16 offset:21504
    ds_read_b64_tr_b16 v[196:197], v17 offset:20480
    ds_read_b64_tr_b16 v[198:199], v17 offset:21504
    s_nop 0
    ds_read_b64_tr_b16 v[200:201], v18 offset:20480
    ds_read_b64_tr_b16 v[202:203], v18 offset:21504
    ds_read_b64_tr_b16 v[204:205], v19 offset:20480
    ds_read_b64_tr_b16 v[206:207], v19 offset:21504
    s_add_u32 m0, s30, 0
    s_lshl_b32 s34, s46, 19
    buffer_load_dwordx4 v6, s[20:23], s34 offen offset:0 lds
    s_nop 0
    s_nop 0
    s_add_u32 s34, s34, 31744
    buffer_load_dwordx4 v6, s[20:23], s34 offen offset:1024 lds
    s_waitcnt lgkmcnt(8)
    v_mfma_f32_32x32x16_bf16 v[64:79], v[176:179], v[128:131], 0
    ds_read_b64_tr_b16 v[208:209], v16 offset:24576
    ds_read_b64_tr_b16 v[210:211], v16 offset:25600
    ds_read_b64_tr_b16 v[212:213], v17 offset:24576
    ds_read_b64_tr_b16 v[214:215], v17 offset:25600
    v_mfma_f32_32x32x16_bf16 v[80:95], v[180:183], v[128:131], 0
    ds_read_b64_tr_b16 v[216:217], v18 offset:24576
    ds_read_b64_tr_b16 v[218:219], v18 offset:25600
    ds_read_b64_tr_b16 v[220:221], v19 offset:24576
    ds_read_b64_tr_b16 v[222:223], v19 offset:25600
    s_add_u32 s34, s34, 31744
    buffer_load_dwordx4 v6, s[20:23], s34 offen offset:2048 lds
    v_mfma_f32_32x32x16_bf16 v[96:111], v[184:187], v[128:131], 0
    v_mfma_f32_32x32x16_bf16 v[112:127], v[188:191], v[128:131], 0
    s_add_u32 s34, s34, 31744
    buffer_load_dwordx4 v6, s[20:23], s34 offen offset:3072 lds
    s_waitcnt lgkmcnt(8)
    v_mfma_f32_32x32x16_bf16 v[64:79], v[192:195], v[132:135], v[64:79]
    ds_read_b64_tr_b16 v[224:225], v16 offset:28672
    ds_read_b64_tr_b16 v[226:227], v16 offset:29696
    ds_read_b64_tr_b16 v[228:229], v17 offset:28672
    ds_read_b64_tr_b16 v[230:231], v17 offset:29696
    v_mfma_f32_32x32x16_bf16 v[80:95], v[196:199], v[132:135], v[80:95]
    ds_read_b64_tr_b16 v[232:233], v18 offset:28672
    ds_read_b64_tr_b16 v[234:235], v18 offset:29696
    ds_read_b64_tr_b16 v[236:237], v19 offset:28672
    ds_read_b64_tr_b16 v[238:239], v19 offset:29696
    s_add_u32 m0, s30, 65536
    s_lshl_b32 s34, s46, 7
    buffer_load_dwordx4 v240, s[8:11], s34 offen offset:0 lds
    v_mfma_f32_32x32x16_bf16 v[96:111], v[200:203], v[132:135], v[96:111]
    v_mfma_f32_32x32x16_bf16 v[112:127], v[204:207], v[132:135], v[112:127]
    buffer_load_dwordx4 v241, s[8:11], s34 offen offset:1024 lds
    s_waitcnt lgkmcnt(8)
    v_mfma_f32_32x32x16_bf16 v[64:79], v[208:211], v[136:139], v[64:79]
    v_mfma_f32_32x32x16_bf16 v[80:95], v[212:215], v[136:139], v[80:95]
    buffer_load_dwordx4 v242, s[8:11], s34 offen offset:2048 lds
    v_mfma_f32_32x32x16_bf16 v[96:111], v[216:219], v[136:139], v[96:111]
    v_mfma_f32_32x32x16_bf16 v[112:127], v[220:223], v[136:139], v[112:127]
    buffer_load_dwordx4 v243, s[8:11], s34 offen offset:3072 lds
    s_add_u32 s46, s46, 1
    s_cmp_eq_u32 s46, 9
    s_cselect_b32 s46, 0, s46
    s_waitcnt lgkmcnt(0)
    s_waitcnt vmcnt(8)
    s_barrier
    ds_read_b128 v[144:147], v244 offset:0
    ds_read_b128 v[148:151], v245 offset:0
    ds_read_b128 v[152:155], v246 offset:0
    ds_read_b128 v[156:159], v247 offset:0
    ds_read_b64_tr_b16 v[176:177], v16 offset:49152
    ds_read_b64_tr_b16 v[178:179], v16 offset:50176
    ds_read_b64_tr_b16 v[180:181], v17 offset:49152
    ds_read_b64_tr_b16 v[182:183], v17 offset:50176
    ds_read_b64_tr_b16 v[184:185], v18 offset:49152
    ds_read_b64_tr_b16 v[186:187], v18 offset:50176
    ds_read_b64_tr_b16 v[188:189], v19 offset:49152
    ds_read_b64_tr_b16 v[190:191], v19 offset:50176
    v_mfma_f32_32x32x16_bf16 v[64:79], v[224:227], v[140:143], v[64:79]
    ds_read_b64_tr_b16 v[192:193], v16 offset:53248
    ds_read_b64_tr_b16 v[194:195], v16 offset:54272
    ds_read_b64_tr_b16 v[196:197], v17 offset:53248
    ds_read_b64_tr_b16 v[198:199], v17 offset:54272
    v_mfma_f32_32x32x16_bf16 v[80:95], v[228:231], v[140:143], v[80:95]
    ds_read_b64_tr_b16 v[200:201], v18 offset:53248
    ds_read_b64_tr_b16 v[202:203], v18 offset:54272
    ds_read_b64_tr_b16 v[204:205], v19 offset:53248
    ds_read_b64_tr_b16 v[206:207], v19 offset:54272
    s_add_u32 m0, s30, 16384
    s_lshl_b32 s34, s46, 19
    buffer_load_dwordx4 v6, s[20:23], s34 offen offset:0 lds
    v_mfma_f32_32x32x16_bf16 v[96:111], v[232:235], v[140:143], v[96:111]
    v_mfma_f32_32x32x16_bf16 v[112:127], v[236:239], v[140:143], v[112:127]
    s_add_u32 s34, s34, 31744
    buffer_load_dwordx4 v6, s[20:23], s34 offen offset:1024 lds
    s_waitcnt lgkmcnt(8)
    v_mfma_f32_32x32x16_bf16 v[64:79], v[176:179], v[144:147], v[64:79]
    ds_read_b64_tr_b16 v[208:209], v16 offset:57344
    ds_read_b64_tr_b16 v[210:211], v16 offset:58368
    ds_read_b64_tr_b16 v[212:213], v17 offset:57344
    ds_read_b64_tr_b16 v[214:215], v17 offset:58368
    v_mfma_f32_32x32x16_bf16 v[80:95], v[180:183], v[144:147], v[80:95]
    ds_read_b64_tr_b16 v[216:217], v18 offset:57344
    ds_read_b64_tr_b16 v[218:219], v18 offset:58368
    ds_read_b64_tr_b16 v[220:221], v19 offset:57344
    ds_read_b64_tr_b16 v[222:223], v19 offset:58368
    s_add_u32 s34, s34, 31744
    buffer_load_dwordx4 v6, s[20:23], s34 offen offset:2048 lds
    v_mfma_f32_32x32x16_bf16 v[96:111], v[184:187], v[144:147], v[96:111]
    v_mfma_f32_32x32x16_bf16 v[112:127], v[188:191], v[144:147], v[112:127]
    s_add_u32 s34, s34, 31744
    buffer_load_dwordx4 v6, s[20:23], s34 offen offset:3072 lds
    s_waitcnt lgkmcnt(8)
    v_mfma_f32_32x32x16_bf16 v[64:79], v[192:195], v[148:151], v[64:79]
    ds_read_b64_tr_b16 v[224:225], v16 offset:61440
    ds_read_b64_tr_b16 v[226:227], v16 offset:62464
    ds_read_b64_tr_b16 v[228:229], v17 offset:61440
    ds_read_b64_tr_b16 v[230:231], v17 offset:62464
    v_mfma_f32_32x32x16_bf16 v[80:95], v[196:199], v[148:151], v[80:95]
    ds_read_b64_tr_b16 v[232:233], v18 offset:61440
    ds_read_b64_tr_b16 v[234:235], v18 offset:62464
    ds_read_b64_tr_b16 v[236:237], v19 offset:61440
    ds_read_b64_tr_b16 v[238:239], v19 offset:62464
    s_add_u32 m0, s30, 32768
    s_lshl_b32 s34, s46, 7
    buffer_load_dwordx4 v240, s[8:11], s34 offen offset:0 lds
    v_mfma_f32_32x32x16_bf16 v[96:111], v[200:203], v[148:151], v[96:111]
    v_mfma_f32_32x32x16_bf16 v[112:127], v[204:207], v[148:151], v[112:127]
    buffer_load_dwordx4 v241, s[8:11], s34 offen offset:1024 lds
    s_waitcnt lgkmcnt(8)
    v_mfma_f32_32x32x16_bf16 v[64:79], v[208:211], v[152:155], v[64:79]
    v_mfma_f32_32x32x16_bf16 v[80:95], v[212:215], v[152:155], v[80:95]
    buffer_load_dwordx4 v242, s[8:11], s34 offen offset:2048 lds
    v_mfma_f32_32x32x16_bf16 v[96:111], v[216:219], v[152:155], v[96:111]
    v_mfma_f32_32x32x16_bf16 v[112:127], v[220:223], v[152:155], v[112:127]
    buffer_load_dwordx4 v243, s[8:11], s34 offen offset:3072 lds
    s_add_u32 s46, s46, 1
    s_cmp_eq_u32 s46, 9
    s_cselect_b32 s46, 0, s46
    s_waitcnt lgkmcnt(0)
    s_waitcnt vmcnt(8)
    s_barrier
    ds_read_b128 v[128:131], v244 offset:32768
    ds_read_b128 v[132:135], v245 offset:32768
    ds_read_b128 v[136:139], v246 offset:32768
    ds_read_b128 v[140:143], v247 offset:32768
    ds_read_b64_tr_b16 v[176:177], v16 offset:0
    ds_read_b64_tr_b16 v[178:179], v16 offset:1024
    ds_read_b64_tr_b16 v[180:181], v17 offset:0
    ds_read_b64_tr_b16 v[182:183], v17 offset:1024
    ds_read_b64_tr_b16 v[184:185], v18 offset:0
    ds_read_b64_tr_b16 v[186:187], v18 offset:1024
    ds_read_b64_tr_b16 v[188:189], v19 offset:0
    ds_read_b64_tr_b16 v[190:191], v19 offset:1024
    v_mfma_f32_32x32x16_bf16 v[64:79], v[224:227], v[156:159], v[64:79]
    ds_read_b64_tr_b16 v[192:193], v16 offset:4096
    ds_read_b64_tr_b16 v[194:195], v16 offset:5120
    ds_read_b64_tr_b16 v[196:197], v17 offset:4096
    ds_read_b64_tr_b16 v[198:199], v17 offset:5120
    v_mfma_f32_32x32x16_bf16 v[80:95], v[228:231], v[156:159], v[80:95]
    ds_read_b64_tr_b16 v[200:201], v18 offset:4096
    ds_read_b64_tr_b16 v[202:203], v18 offset:5120
    ds_read_b64_tr_b16 v[204:205], v19 offset:4096
    ds_read_b64_tr_b16 v[206:207], v19 offset:5120
    s_add_u32 m0, s30, 49152
    s_lshl_b32 s34, s46, 19
    buffer_load_dwordx4 v6, s[20:23], s34 offen offset:0 lds
    v_mfma_f32_32x32x16_bf16 v[96:111], v[232:235], v[156:159], v[96:111]
    v_mfma_f32_32x32x16_bf16 v[112:127], v[236:239], v[156:159], v[112:127]
    s_add_u32 s34, s34, 31744
    buffer_load_dwordx4 v6, s[20:23], s34 offen offset:1024 lds
    s_waitcnt lgkmcnt(8)
    v_mfma_f32_32x32x16_bf16 v[64:79], v[176:179], v[128:131], v[64:79]
    ds_read_b64_tr_b16 v[208:209], v16 offset:8192
    ds_read_b64_tr_b16 v[210:211], v16 offset:9216
    ds_read_b64_tr_b16 v[212:213], v17 offset:8192
    ds_read_b64_tr_b16 v[214:215], v17 offset:9216
    v_mfma_f32_32x32x16_bf16 v[80:95], v[180:183], v[128:131], v[80:95]
    ds_read_b64_tr_b16 v[216:217], v18 offset:8192
    ds_read_b64_tr_b16 v[218:219], v18 offset:9216
    ds_read_b64_tr_b16 v[220:221], v19 offset:8192
    ds_read_b64_tr_b16 v[222:223], v19 offset:9216
    s_add_u32 s34, s34, 31744
    buffer_load_dwordx4 v6, s[20:23], s34 offen offset:2048 lds
    v_mfma_f32_32x32x16_bf16 v[96:111], v[184:187], v[128:131], v[96:111]
    v_mfma_f32_32x32x16_bf16 v[112:127], v[188:191], v[128:131], v[112:127]
    s_add_u32 s34, s34, 31744
    buffer_load_dwordx4 v6, s[20:23], s34 offen offset:3072 lds
    s_waitcnt lgkmcnt(8)
    v_mfma_f32_32x32x16_bf16 v[64:79], v[192:195], v[132:135], v[64:79]
    ds_read_b64_tr_b16 v[224:225], v16 offset:12288
    ds_read_b64_tr_b16 v[226:227], v16 offset:13312
    ds_read_b64_tr_b16 v[228:229], v17 offset:12288
    ds_read_b64_tr_b16 v[230:231], v17 offset:13312
    v_mfma_f32_32x32x16_bf16 v[80:95], v[196:199], v[132:135], v[80:95]
    ds_read_b64_tr_b16 v[232:233], v18 offset:12288
    ds_read_b64_tr_b16 v[234:235], v18 offset:13312
    ds_read_b64_tr_b16 v[236:237], v19 offset:12288
    ds_read_b64_tr_b16 v[238:239], v19 offset:13312
    s_add_u32 m0, s30, 65536
    s_lshl_b32 s34, s46, 7
    buffer_load_dwordx4 v240, s[8:11], s34 offen offset:0 lds
    v_mfma_f32_32x32x16_bf16 v[96:111], v[200:203], v[132:135], v[96:111]
    v_mfma_f32_32x32x16_bf16 v[112:127], v[204:207], v[132:135], v[112:127]
    buffer_load_dwordx4 v241, s[8:11], s34 offen offset:1024 lds
    s_waitcnt lgkmcnt(8)
    v_mfma_f32_32x32x16_bf16 v[64:79], v[208:211], v[136:139], v[64:79]
    v_mfma_f32_32x32x16_bf16 v[80:95], v[212:215], v[136:139], v[80:95]
    buffer_load_dwordx4 v242, s[8:11], s34 offen offset:2048 lds
    v_mfma_f32_32x32x16_bf16 v[96:111], v[216:219], v[136:139], v[96:111]
    v_mfma_f32_32x32x16_bf16 v[112:127], v[220:223], v[136:139], v[112:127]
    buffer_load_dwordx4 v243, s[8:11], s34 offen offset:3072 lds
    s_add_u32 s46, s46, 1
    s_cmp_eq_u32 s46, 9
    s_cselect_b32 s46, 0, s46
    s_waitcnt lgkmcnt(0)
    s_waitcnt vmcnt(8)
    s_barrier
    ds_read_b128 v[144:147], v244 offset:0
    ds_read_b128 v[148:151], v245 offset:0
    ds_read_b128 v[152:155], v246 offset:0
    ds_read_b128 v[156:159], v247 offset:0
    ds_read_b64_tr_b16 v[176:177], v16 offset:16384
    ds_read_b64_tr_b16 v[178:179], v16 offset:17408
    ds_read_b64_tr_b16 v[180:181], v17 offset:16384
    ds_read_b64_tr_b16 v[182:183], v17 offset:17408
    ds_read_b64_tr_b16 v[184:185], v18 offset:16384
    ds_read_b64_tr_b16 v[186:187], v18 offset:17408
    ds_read_b64_tr_b16 v[188:189], v19 offset:16384
    ds_read_b64_tr_b16 v[190:191], v19 offset:17408
    v_mfma_f32_32x32x16_bf16 v[64:79], v[224:227], v[140:143], v[64:79]
    ds_read_b64_tr_b16 v[192:193], v16 offset:20480
    ds_read_b64_tr_b16 v[194:195], v16 offset:21504
    ds_read_b64_tr_b16 v[196:197], v17 offset:20480
    ds_read_b64_tr_b16 v[198:199], v17 offset:21504
    v_mfma_f32_32x32x16_bf16 v[80:95], v[228:231], v[140:143], v[80:95]
    ds_read_b64_tr_b16 v[200:201], v18 offset:20480
    ds_read_b64_tr_b16 v[202:203], v18 offset:21504
    ds_read_b64_tr_b16 v[204:205], v19 offset:20480
    ds_read_b64_tr_b16 v[206:207], v19 offset:21504
    s_add_u32 m0, s30, 0
    s_lshl_b32 s34, s46, 19
    buffer_load_dwordx4 v6, s[20:23], s34 offen offset:0 lds
    v_mfma_f32_32x32x16_bf16 v[96:111], v[232:235], v[140:143], v[96:111]
    v_mfma_f32_32x32x16_bf16 v[112:127], v[236:239], v[140:143], v[112:127]
    s_add_u32 s34, s34, 31744
    buffer_load_dwordx4 v6, s[20:23], s34 offen offset:1024 lds
    s_waitcnt lgkmcnt(8)
    v_mfma_f32_32x32x16_bf16 v[64:79], v[176:179], v[144:147], v[64:79]
    ds_read_b64_tr_b16 v[208:209], v16 offset:24576
    ds_read_b64_tr_b16 v[210:211], v16 offset:25600
    ds_read_b64_tr_b16 v[212:213], v17 offset:24576
    ds_read_b64_tr_b16 v[214:215], v17 offset:25600
    v_mfma_f32_32x32x16_bf16 v[80:95], v[180:183], v[144:147], v[80:95]
    ds_read_b64_tr_b16 v[216:217], v18 offset:24576
    ds_read_b64_tr_b16 v[218:219], v18 offset:25600
    ds_read_b64_tr_b16 v[220:221], v19 offset:24576
    ds_read_b64_tr_b16 v[222:223], v19 offset:25600
    s_add_u32 s34, s34, 31744
    buffer_load_dwordx4 v6, s[20:23], s34 offen offset:2048 lds
    v_mfma_f32_32x32x16_bf16 v[96:111], v[184:187], v[144:147], v[96:111]
    v_mfma_f32_32x32x16_bf16 v[112:127], v[188:191], v[144:147], v[112:127]
    s_add_u32 s34, s34, 31744
    buffer_load_dwordx4 v6, s[20:23], s34 offen offset:3072 lds
    s_waitcnt lgkmcnt(8)
    v_mfma_f32_32x32x16_bf16 v[64:79], v[192:195], v[148:151], v[64:79]
    ds_read_b64_tr_b16 v[224:225], v16 offset:28672
    ds_read_b64_tr_b16 v[226:227], v16 offset:29696
    ds_read_b64_tr_b16 v[228:229], v17 offset:28672
    ds_read_b64_tr_b16 v[230:231], v17 offset:29696
    v_mfma_f32_32x32x16_bf16 v[80:95], v[196:199], v[148:151], v[80:95]
    ds_read_b64_tr_b16 v[232:233], v18 offset:28672
    ds_read_b64_tr_b16 v[234:235], v18 offset:29696
    ds_read_b64_tr_b16 v[236:237], v19 offset:28672
    ds_read_b64_tr_b16 v[238:239], v19 offset:29696
    s_add_u32 m0, s30, 32768
    s_lshl_b32 s34, s46, 7
    buffer_load_dwordx4 v240, s[8:11], s34 offen offset:0 lds
    v_mfma_f32_32x32x16_bf16 v[96:111], v[200:203], v[148:151], v[96:111]
    v_mfma_f32_32x32x16_bf16 v[112:127], v[204:207], v[148:151], v[112:127]
    buffer_load_dwordx4 v241, s[8:11], s34 offen offset:1024 lds
    s_waitcnt lgkmcnt(8)
    v_mfma_f32_32x32x16_bf16 v[64:79], v[208:211], v[152:155], v[64:79]
    v_mfma_f32_32x32x16_bf16 v[80:95], v[212:215], v[152:155], v[80:95]
    buffer_load_dwordx4 v242, s[8:11], s34 offen offset:2048 lds
    v_mfma_f32_32x32x16_bf16 v[96:111], v[216:219], v[152:155], v[96:111]
    v_mfma_f32_32x32x16_bf16 v[112:127], v[220:223], v[152:155], v[112:127]
    buffer_load_dwordx4 v243, s[8:11], s34 offen offset:3072 lds
    s_add_u32 s46, s46, 1
    s_cmp_eq_u32 s46, 9
    s_cselect_b32 s46, 0, s46
    s_waitcnt lgkmcnt(0)
    s_waitcnt vmcnt(8)
    s_barrier
    ds_read_b128 v[128:131], v244 offset:32768
    ds_read_b128 v[132:135], v245 offset:32768
    ds_read_b128 v[136:139], v246 offset:32768
    ds_read_b128 v[140:143], v247 offset:32768
    ds_read_b64_tr_b16 v[176:177], v16 offset:49152
    ds_read_b64_tr_b16 v[178:179], v16 offset:50176
    ds_read_b64_tr_b16 v[180:181], v17 offset:49152
    ds_read_b64_tr_b16 v[182:183], v17 offset:50176
    ds_read_b64_tr_b16 v[184:185], v18 offset:49152
    ds_read_b64_tr_b16 v[186:187], v18 offset:50176
    ds_read_b64_tr_b16 v[188:189], v19 offset:49152
    ds_read_b64_tr_b16 v[190:191], v19 offset:50176
    v_mfma_f32_32x32x16_bf16 v[64:79], v[224:227], v[156:159], v[64:79]
    ds_read_b64_tr_b16 v[192:193], v16 offset:53248
    ds_read_b64_tr_b16 v[194:195], v16 offset:54272
    ds_read_b64_tr_b16 v[196:197], v17 offset:53248
    ds_read_b64_tr_b16 v[198:199], v17 offset:54272
    v_mfma_f32_32x32x16_bf16 v[80:95], v[228:231], v[156:159], v[80:95]
    ds_read_b64_tr_b16 v[200:201], v18 offset:53248
    ds_read_b64_tr_b16 v[202:203], v18 offset:54272
    ds_read_b64_tr_b16 v[204:205], v19 offset:53248
    ds_read_b64_tr_b16 v[206:207], v19 offset:54272
    s_add_u32 m0, s30, 16384
    s_lshl_b32 s34, s46, 19
    buffer_load_dwordx4 v6, s[20:23], s34 offen offset:0 lds
    v_mfma_f32_32x32x16_bf16 v[96:111], v[232:235], v[156:159], v[96:111]
    v_mfma_f32_32x32x16_bf16 v[112:127], v[236:239], v[156:159], v[112:127]
    s_add_u32 s34, s34, 31744
    buffer_load_dwordx4 v6, s[20:23], s34 offen offset:1024 lds
    s_waitcnt lgkmcnt(8)
    v_mfma_f32_32x32x16_bf16 v[64:79], v[176:179], v[128:131], v[64:79]
    ds_read_b64_tr_b16 v[208:209], v16 offset:57344
    ds_read_b64_tr_b16 v[210:211], v16 offset:58368
    ds_read_b64_tr_b16 v[212:213], v17 offset:57344
    ds_read_b64_tr_b16 v[214:215], v17 offset:58368
    v_mfma_f32_32x32x16_bf16 v[80:95], v[180:183], v[128:131], v[80:95]
    ds_read_b64_tr_b16 v[216:217], v18 offset:57344
    ds_read_b64_tr_b16 v[218:219], v18 offset:58368
    ds_read_b64_tr_b16 v[220:221], v19 offset:57344
    ds_read_b64_tr_b16 v[222:223], v19 offset:58368
    s_add_u32 s34, s34, 31744
    buffer_load_dwordx4 v6, s[20:23], s34 offen offset:2048 lds
    v_mfma_f32_32x32x16_bf16 v[96:111], v[184:187], v[128:131], v[96:111]
    v_mfma_f32_32x32x16_bf16 v[112:127], v[188:191], v[128:131], v[112:127]
    s_add_u32 s34, s34, 31744
    buffer_load_dwordx4 v6, s[20:23], s34 offen offset:3072 lds
    s_waitcnt lgkmcnt(8)
    v_mfma_f32_32x32x16_bf16 v[64:79], v[192:195], v[132:135], v[64:79]
    ds_read_b64_tr_b16 v[224:225], v16 offset:61440
    ds_read_b64_tr_b16 v[226:227], v16 offset:62464
    ds_read_b64_tr_b16 v[228:229], v17 offset:61440
    ds_read_b64_tr_b16 v[230:231], v17 offset:62464
    v_mfma_f32_32x32x16_bf16 v[80:95], v[196:199], v[132:135], v[80:95]
    ds_read_b64_tr_b16 v[232:233], v18 offset:61440
    ds_read_b64_tr_b16 v[234:235], v18 offset:62464
    ds_read_b64_tr_b16 v[236:237], v19 offset:61440
    ds_read_b64_tr_b16 v[238:239], v19 offset:62464
    s_add_u32 m0, s30, 65536
    s_lshl_b32 s34, s46, 7
    buffer_load_dwordx4 v240, s[8:11], s34 offen offset:0 lds
    v_mfma_f32_32x32x16_bf16 v[96:111], v[200:203], v[132:135], v[96:111]
    v_mfma_f32_32x32x16_bf16 v[112:127], v[204:207], v[132:135], v[112:127]
    buffer_load_dwordx4 v241, s[8:11], s34 offen offset:1024 lds
    s_waitcnt lgkmcnt(8)
    v_mfma_f32_32x32x16_bf16 v[64:79], v[208:211], v[136:139], v[64:79]
    v_mfma_f32_32x32x16_bf16 v[80:95], v[212:215], v[136:139], v[80:95]
    buffer_load_dwordx4 v242, s[8:11], s34 offen offset:2048 lds
    v_mfma_f32_32x32x16_bf16 v[96:111], v[216:219], v[136:139], v[96:111]
    v_mfma_f32_32x32x16_bf16 v[112:127], v[220:223], v[136:139], v[112:127]
    buffer_load_dwordx4 v243, s[8:11], s34 offen offset:3072 lds
    s_add_u32 s46, s46, 1
    s_cmp_eq_u32 s46, 9
    s_cselect_b32 s46, 0, s46
    s_waitcnt lgkmcnt(0)
    s_waitcnt vmcnt(8)
    s_barrier
    ds_read_b128 v[144:147], v244 offset:0
    ds_read_b128 v[148:151], v245 offset:0
    ds_read_b128 v[152:155], v246 offset:0
    ds_read_b128 v[156:159], v247 offset:0
    ds_read_b64_tr_b16 v[176:177], v16 offset:0
    ds_read_b64_tr_b16 v[178:179], v16 offset:1024
    ds_read_b64_tr_b16 v[180:181], v17 offset:0
    ds_read_b64_tr_b16 v[182:183], v17 offset:1024
    ds_read_b64_tr_b16 v[184:185], v18 offset:0
    ds_read_b64_tr_b16 v[186:187], v18 offset:1024
    ds_read_b64_tr_b16 v[188:189], v19 offset:0
    ds_read_b64_tr_b16 v[190:191], v19 offset:1024
    v_mfma_f32_32x32x16_bf16 v[64:79], v[224:227], v[140:143], v[64:79]
    ds_read_b64_tr_b16 v[192:193], v16 offset:4096
    ds_read_b64_tr_b16 v[194:195], v16 offset:5120
    ds_read_b64_tr_b16 v[196:197], v17 offset:4096
    ds_read_b64_tr_b16 v[198:199], v17 offset:5120
    v_mfma_f32_32x32x16_bf16 v[80:95], v[228:231], v[140:143], v[80:95]
    ds_read_b64_tr_b16 v[200:201], v18 offset:4096
    ds_read_b64_tr_b16 v[202:203], v18 offset:5120
    ds_read_b64_tr_b16 v[204:205], v19 offset:4096
    ds_read_b64_tr_b16 v[206:207], v19 offset:5120
    s_add_u32 m0, s30, 49152
    s_lshl_b32 s34, s46, 19
    buffer_load_dwordx4 v6, s[20:23], s34 offen offset:0 lds
    v_mfma_f32_32x32x16_bf16 v[96:111], v[232:235], v[140:143], v[96:111]
    v_mfma_f32_32x32x16_bf16 v[112:127], v[236:239], v[140:143], v[112:127]
    s_add_u32 s34, s34, 31744
    buffer_load_dwordx4 v6, s[20:23], s34 offen offset:1024 lds
    s_waitcnt lgkmcnt(8)
    v_mfma_f32_32x32x16_bf16 v[64:79], v[176:179], v[144:147], v[64:79]
    ds_read_b64_tr_b16 v[208:209], v16 offset:8192
    ds_read_b64_tr_b16 v[210:211], v16 offset:9216
    ds_read_b64_tr_b16 v[212:213], v17 offset:8192
    ds_read_b64_tr_b16 v[214:215], v17 offset:9216
    v_mfma_f32_32x32x16_bf16 v[80:95], v[180:183], v[144:147], v[80:95]
    ds_read_b64_tr_b16 v[216:217], v18 offset:8192
    ds_read_b64_tr_b16 v[218:219], v18 offset:9216
    ds_read_b64_tr_b16 v[220:221], v19 offset:8192
    ds_read_b64_tr_b16 v[222:223], v19 offset:9216
    s_add_u32 s34, s34, 31744
    buffer_load_dwordx4 v6, s[20:23], s34 offen offset:2048 lds
    v_mfma_f32_32x32x16_bf16 v[96:111], v[184:187], v[144:147], v[96:111]
    v_mfma_f32_32x32x16_bf16 v[112:127], v[188:191], v[144:147], v[112:127]
    s_add_u32 s34, s34, 31744
    buffer_load_dwordx4 v6, s[20:23], s34 offen offset:3072 lds
    s_waitcnt lgkmcnt(8)
    v_mfma_f32_32x32x16_bf16 v[64:79], v[192:195], v[148:151], v[64:79]
    ds_read_b64_tr_b16 v[224:225], v16 offset:12288
    ds_read_b64_tr_b16 v[226:227], v16 offset:13312
    ds_read_b64_tr_b16 v[228:229], v17 offset:12288
    ds_read_b64_tr_b16 v[230:231], v17 offset:13312
    v_mfma_f32_32x32x16_bf16 v[80:95], v[196:199], v[148:151], v[80:95]
    ds_read_b64_tr_b16 v[232:233], v18 offset:12288
    ds_read_b64_tr_b16 v[234:235], v18 offset:13312
    ds_read_b64_tr_b16 v[236:237], v19 offset:12288
    ds_read_b64_tr_b16 v[238:239], v19 offset:13312
    s_add_u32 m0, s30, 32768
    s_lshl_b32 s34, s46, 7
    buffer_load_dwordx4 v240, s[8:11], s34 offen offset:0 lds
    v_mfma_f32_32x32x16_bf16 v[96:111], v[200:203], v[148:151], v[96:111]
    v_mfma_f32_32x32x16_bf16 v[112:127], v[204:207], v[148:151], v[112:127]
    buffer_load_dwordx4 v241, s[8:11], s34 offen offset:1024 lds
    s_waitcnt lgkmcnt(8)
    v_mfma_f32_32x32x16_bf16 v[64:79], v[208:211], v[152:155], v[64:79]
    v_mfma_f32_32x32x16_bf16 v[80:95], v[212:215], v[152:155], v[80:95]
    buffer_load_dwordx4 v242, s[8:11], s34 offen offset:2048 lds
    v_mfma_f32_32x32x16_bf16 v[96:111], v[216:219], v[152:155], v[96:111]
    v_mfma_f32_32x32x16_bf16 v[112:127], v[220:223], v[152:155], v[112:127]
    buffer_load_dwordx4 v243, s[8:11], s34 offen offset:3072 lds
    s_add_u32 s46, s46, 1
    s_cmp_eq_u32 s46, 9
    s_cselect_b32 s46, 0, s46
    s_waitcnt lgkmcnt(0)
    s_waitcnt vmcnt(8)
    s_barrier
    ds_read_b128 v[128:131], v244 offset:32768
    ds_read_b128 v[132:135], v245 offset:32768
    ds_read_b128 v[136:139], v246 offset:32768
    ds_read_b128 v[140:143], v247 offset:32768
    ds_read_b64_tr_b16 v[176:177], v16 offset:16384
    ds_read_b64_tr_b16 v[178:179], v16 offset:17408
    ds_read_b64_tr_b16 v[180:181], v17 offset:16384
    ds_read_b64_tr_b16 v[182:183], v17 offset:17408
    ds_read_b64_tr_b16 v[184:185], v18 offset:16384
    ds_read_b64_tr_b16 v[186:187], v18 offset:17408
    ds_read_b64_tr_b16 v[188:189], v19 offset:16384
    ds_read_b64_tr_b16 v[190:191], v19 offset:17408
    v_mfma_f32_32x32x16_bf16 v[64:79], v[224:227], v[156:159], v[64:79]
    ds_read_b64_tr_b16 v[192:193], v16 offset:20480
    ds_read_b64_tr_b16 v[194:195], v16 offset:21504
    ds_read_b64_tr_b16 v[196:197], v17 offset:20480
    ds_read_b64_tr_b16 v[198:199], v17 offset:21504
    v_mfma_f32_32x32x16_bf16 v[80:95], v[228:231], v[156:159], v[80:95]
    ds_read_b64_tr_b16 v[200:201], v18 offset:20480
    ds_read_b64_tr_b16 v[202:203], v18 offset:21504
    ds_read_b64_tr_b16 v[204:205], v19 offset:20480
    ds_read_b64_tr_b16 v[206:207], v19 offset:21504
    s_add_u32 m0, s30, 0
    s_lshl_b32 s34, s46, 19
    buffer_load_dwordx4 v6, s[20:23], s34 offen offset:0 lds
    v_mfma_f32_32x32x16_bf16 v[96:111], v[232:235], v[156:159], v[96:111]
    v_mfma_f32_32x32x16_bf16 v[112:127], v[236:239], v[156:159], v[112:127]
    s_add_u32 s34, s34, 31744
    buffer_load_dwordx4 v6, s[20:23], s34 offen offset:1024 lds
    s_waitcnt lgkmcnt(8)
    v_mfma_f32_32x32x16_bf16 v[64:79], v[176:179], v[128:131], v[64:79]
    ds_read_b64_tr_b16 v[208:209], v16 offset:24576
    ds_read_b64_tr_b16 v[210:211], v16 offset:25600
    ds_read_b64_tr_b16 v[212:213], v17 offset:24576
    ds_read_b64_tr_b16 v[214:215], v17 offset:25600
    v_mfma_f32_32x32x16_bf16 v[80:95], v[180:183], v[128:131], v[80:95]
    ds_read_b64_tr_b16 v[216:217], v18 offset:24576
    ds_read_b64_tr_b16 v[218:219], v18 offset:25600
    ds_read_b64_tr_b16 v[220:221], v19 offset:24576
    ds_read_b64_tr_b16 v[222:223], v19 offset:25600
    s_add_u32 s34, s34, 31744
    buffer_load_dwordx4 v6, s[20:23], s34 offen offset:2048 lds
    v_mfma_f32_32x32x16_bf16 v[96:111], v[184:187], v[128:131], v[96:111]
    v_mfma_f32_32x32x16_bf16 v[112:127], v[188:191], v[128:131], v[112:127]
    s_add_u32 s34, s34, 31744
    buffer_load_dwordx4 v6, s[20:23], s34 offen offset:3072 lds
    s_waitcnt lgkmcnt(8)
    v_mfma_f32_32x32x16_bf16 v[64:79], v[192:195], v[132:135], v[64:79]
    ds_read_b64_tr_b16 v[224:225], v16 offset:28672
    ds_read_b64_tr_b16 v[226:227], v16 offset:29696
    ds_read_b64_tr_b16 v[228:229], v17 offset:28672
    ds_read_b64_tr_b16 v[230:231], v17 offset:29696
    v_mfma_f32_32x32x16_bf16 v[80:95], v[196:199], v[132:135], v[80:95]
    ds_read_b64_tr_b16 v[232:233], v18 offset:28672
    ds_read_b64_tr_b16 v[234:235], v18 offset:29696
    ds_read_b64_tr_b16 v[236:237], v19 offset:28672
    ds_read_b64_tr_b16 v[238:239], v19 offset:29696
    s_add_u32 m0, s30, 65536
    s_lshl_b32 s34, s46, 7
    buffer_load_dwordx4 v240, s[8:11], s34 offen offset:0 lds
    v_mfma_f32_32x32x16_bf16 v[96:111], v[200:203], v[132:135], v[96:111]
    v_mfma_f32_32x32x16_bf16 v[112:127], v[204:207], v[132:135], v[112:127]
    buffer_load_dwordx4 v241, s[8:11], s34 offen offset:1024 lds
    s_waitcnt lgkmcnt(8)
    v_mfma_f32_32x32x16_bf16 v[64:79], v[208:211], v[136:139], v[64:79]
    v_mfma_f32_32x32x16_bf16 v[80:95], v[212:215], v[136:139], v[80:95]
    buffer_load_dwordx4 v242, s[8:11], s34 offen offset:2048 lds
    v_mfma_f32_32x32x16_bf16 v[96:111], v[216:219], v[136:139], v[96:111]
    v_mfma_f32_32x32x16_bf16 v[112:127], v[220:223], v[136:139], v[112:127]
    buffer_load_dwordx4 v243, s[8:11], s34 offen offset:3072 lds
    s_add_u32 s46, s46, 1
    s_cmp_eq_u32 s46, 9
    s_cselect_b32 s46, 0, s46
    s_waitcnt lgkmcnt(0)
    s_waitcnt vmcnt(8)
    s_barrier
    ds_read_b128 v[144:147], v244 offset:0
    ds_read_b128 v[148:151], v245 offset:0
    ds_read_b128 v[152:155], v246 offset:0
    ds_read_b128 v[156:159], v247 offset:0
    ds_read_b64_tr_b16 v[176:177], v16 offset:49152
    ds_read_b64_tr_b16 v[178:179], v16 offset:50176
    ds_read_b64_tr_b16 v[180:181], v17 offset:49152
    ds_read_b64_tr_b16 v[182:183], v17 offset:50176
    ds_read_b64_tr_b16 v[184:185], v18 offset:49152
    ds_read_b64_tr_b16 v[186:187], v18 offset:50176
    ds_read_b64_tr_b16 v[188:189], v19 offset:49152
    ds_read_b64_tr_b16 v[190:191], v19 offset:50176
    v_mfma_f32_32x32x16_bf16 v[64:79], v[224:227], v[140:143], v[64:79]
    ds_read_b64_tr_b16 v[192:193], v16 offset:53248
    ds_read_b64_tr_b16 v[194:195], v16 offset:54272
    ds_read_b64_tr_b16 v[196:197], v17 offset:53248
    ds_read_b64_tr_b16 v[198:199], v17 offset:54272
    v_mfma_f32_32x32x16_bf16 v[80:95], v[228:231], v[140:143], v[80:95]
    ds_read_b64_tr_b16 v[200:201], v18 offset:53248
    ds_read_b64_tr_b16 v[202:203], v18 offset:54272
    ds_read_b64_tr_b16 v[204:205], v19 offset:53248
    ds_read_b64_tr_b16 v[206:207], v19 offset:54272
    s_add_u32 m0, s30, 16384
    s_nop 0
    buffer_load_dwordx4 v1, s[12:15], s31 offen offset:0 nt lds
    v_mfma_f32_32x32x16_bf16 v[96:111], v[232:235], v[140:143], v[96:111]
    v_mfma_f32_32x32x16_bf16 v[112:127], v[236:239], v[140:143], v[112:127]
    buffer_load_dwordx4 v2, s[12:15], s31 offen offset:1024 nt lds
    s_waitcnt lgkmcnt(8)
    v_mfma_f32_32x32x16_bf16 v[64:79], v[176:179], v[144:147], v[64:79]
    ds_read_b64_tr_b16 v[208:209], v16 offset:57344
    ds_read_b64_tr_b16 v[210:211], v16 offset:58368
    ds_read_b64_tr_b16 v[212:213], v17 offset:57344
    ds_read_b64_tr_b16 v[214:215], v17 offset:58368
    v_mfma_f32_32x32x16_bf16 v[80:95], v[180:183], v[144:147], v[80:95]
    ds_read_b64_tr_b16 v[216:217], v18 offset:57344
    ds_read_b64_tr_b16 v[218:219], v18 offset:58368
    ds_read_b64_tr_b16 v[220:221], v19 offset:57344
    ds_read_b64_tr_b16 v[222:223], v19 offset:58368
    buffer_load_dwordx4 v3, s[12:15], s31 offen offset:2048 nt lds
    v_mfma_f32_32x32x16_bf16 v[96:111], v[184:187], v[144:147], v[96:111]
    v_mfma_f32_32x32x16_bf16 v[112:127], v[188:191], v[144:147], v[112:127]
    buffer_load_dwordx4 v4, s[12:15], s31 offen offset:3072 nt lds
    s_add_u32 s31, s31, 16384
    s_and_b32 s31, s31, 0x3ffff
    s_waitcnt lgkmcnt(8)
    v_mfma_f32_32x32x16_bf16 v[64:79], v[192:195], v[148:151], v[64:79]
    ds_read_b64_tr_b16 v[224:225], v16 offset:61440
    ds_read_b64_tr_b16 v[226:227], v16 offset:62464
    ds_read_b64_tr_b16 v[228:229], v17 offset:61440
    ds_read_b64_tr_b16 v[230:231], v17 offset:62464
    v_mfma_f32_32x32x16_bf16 v[80:95], v[196:199], v[148:151], v[80:95]
    ds_read_b64_tr_b16 v[232:233], v18 offset:61440
    ds_read_b64_tr_b16 v[234:235], v18 offset:62464
    ds_read_b64_tr_b16 v[236:237], v19 offset:61440
    ds_read_b64_tr_b16 v[238:239], v19 offset:62464
    s_add_u32 m0, s30, 32768
    s_nop 0
    buffer_load_dwordx4 v5, s[16:19], s32 offen offset:0 nt lds
    v_mfma_f32_32x32x16_bf16 v[96:111], v[200:203], v[148:151], v[96:111]
    v_mfma_f32_32x32x16_bf16 v[112:127], v[204:207], v[148:151], v[112:127]
    buffer_load_dwordx4 v5, s[16:19], s32 offen offset:1024 nt lds
    s_waitcnt lgkmcnt(8)
    v_mfma_f32_32x32x16_bf16 v[64:79], v[208:211], v[152:155], v[64:79]
    v_mfma_f32_32x32x16_bf16 v[80:95], v[212:215], v[152:155], v[80:95]
    buffer_load_dwordx4 v5, s[16:19], s32 offen offset:2048 nt lds
    v_mfma_f32_32x32x16_bf16 v[96:111], v[216:219], v[152:155], v[96:111]
    v_mfma_f32_32x32x16_bf16 v[112:127], v[220:223], v[152:155], v[112:127]
    buffer_load_dwordx4 v5, s[16:19], s32 offen offset:3072 nt lds
    s_add_u32 s32, s32, 16384
    s_and_b32 s32, s32, 0x3ffff
    s_waitcnt lgkmcnt(0)
    s_waitcnt vmcnt(8)
    s_barrier
    ds_read_b128 v[128:131], v244 offset:32768
    ds_read_b128 v[132:135], v245 offset:32768
    ds_read_b128 v[136:139], v246 offset:32768
    ds_read_b128 v[140:143], v247 offset:32768
    ds_read_b64_tr_b16 v[176:177], v16 offset:0
    ds_read_b64_tr_b16 v[178:179], v16 offset:1024
    ds_read_b64_tr_b16 v[180:181], v17 offset:0
    ds_read_b64_tr_b16 v[182:183], v17 offset:1024
    ds_read_b64_tr_b16 v[184:185], v18 offset:0
    ds_read_b64_tr_b16 v[186:187], v18 offset:1024
    ds_read_b64_tr_b16 v[188:189], v19 offset:0
    ds_read_b64_tr_b16 v[190:191], v19 offset:1024
    v_mfma_f32_32x32x16_bf16 v[64:79], v[224:227], v[156:159], v[64:79]
    ds_read_b64_tr_b16 v[192:193], v16 offset:4096
    ds_read_b64_tr_b16 v[194:195], v16 offset:5120
    ds_read_b64_tr_b16 v[196:197], v17 offset:4096
    ds_read_b64_tr_b16 v[198:199], v17 offset:5120
    v_mfma_f32_32x32x16_bf16 v[80:95], v[228:231], v[156:159], v[80:95]
    ds_read_b64_tr_b16 v[200:201], v18 offset:4096
    ds_read_b64_tr_b16 v[202:203], v18 offset:5120
    ds_read_b64_tr_b16 v[204:205], v19 offset:4096
    ds_read_b64_tr_b16 v[206:207], v19 offset:5120
    s_add_u32 m0, s30, 49152
    s_nop 0
    buffer_load_dwordx4 v1, s[12:15], s31 offen offset:0 nt lds
    v_mfma_f32_32x32x16_bf16 v[96:111], v[232:235], v[156:159], v[96:111]
    v_mfma_f32_32x32x16_bf16 v[112:127], v[236:239], v[156:159], v[112:127]
    buffer_load_dwordx4 v2, s[12:15], s31 offen offset:1024 nt lds
    s_waitcnt lgkmcnt(8)
    v_mfma_f32_32x32x16_bf16 v[64:79], v[176:179], v[128:131], v[64:79]
    ds_read_b64_tr_b16 v[208:209], v16 offset:8192
    ds_read_b64_tr_b16 v[210:211], v16 offset:9216
    ds_read_b64_tr_b16 v[212:213], v17 offset:8192
    ds_read_b64_tr_b16 v[214:215], v17 offset:9216
    v_mfma_f32_32x32x16_bf16 v[80:95], v[180:183], v[128:131], v[80:95]
    ds_read_b64_tr_b16 v[216:217], v18 offset:8192
    ds_read_b64_tr_b16 v[218:219], v18 offset:9216
    ds_read_b64_tr_b16 v[220:221], v19 offset:8192
    ds_read_b64_tr_b16 v[222:223], v19 offset:9216
    buffer_load_dwordx4 v3, s[12:15], s31 offen offset:2048 nt lds
    v_mfma_f32_32x32x16_bf16 v[96:111], v[184:187], v[128:131], v[96:111]
    v_mfma_f32_32x32x16_bf16 v[112:127], v[188:191], v[128:131], v[112:127]
    buffer_load_dwordx4 v4, s[12:15], s31 offen offset:3072 nt lds
    s_add_u32 s31, s31, 16384
    s_and_b32 s31, s31, 0x3ffff
    s_waitcnt lgkmcnt(8)
    v_mfma_f32_32x32x16_bf16 v[64:79], v[192:195], v[132:135], v[64:79]
    ds_read_b64_tr_b16 v[224:225], v16 offset:12288
    ds_read_b64_tr_b16 v[226:227], v16 offset:13312
    ds_read_b64_tr_b16 v[228:229], v17 offset:12288
    ds_read_b64_tr_b16 v[230:231], v17 offset:13312
    v_mfma_f32_32x32x16_bf16 v[80:95], v[196:199], v[132:135], v[80:95]
    ds_read_b64_tr_b16 v[232:233], v18 offset:12288
    ds_read_b64_tr_b16 v[234:235], v18 offset:13312
    ds_read_b64_tr_b16 v[236:237], v19 offset:12288
    ds_read_b64_tr_b16 v[238:239], v19 offset:13312
    v_mfma_f32_32x32x16_bf16 v[96:111], v[200:203], v[132:135], v[96:111]
    v_mfma_f32_32x32x16_bf16 v[112:127], v[204:207], v[132:135], v[112:127]
    s_waitcnt lgkmcnt(8)
    v_mfma_f32_32x32x16_bf16 v[64:79], v[208:211], v[136:139], v[64:79]
    v_mfma_f32_32x32x16_bf16 v[80:95], v[212:215], v[136:139], v[80:95]
    v_mfma_f32_32x32x16_bf16 v[96:111], v[216:219], v[136:139], v[96:111]
    v_mfma_f32_32x32x16_bf16 v[112:127], v[220:223], v[136:139], v[112:127]
    s_waitcnt lgkmcnt(0)
    v_mfma_f32_32x32x16_bf16 v[64:79], v[224:227], v[140:143], v[64:79]
    v_mfma_f32_32x32x16_bf16 v[80:95], v[228:231], v[140:143], v[80:95]
    v_mfma_f32_32x32x16_bf16 v[96:111], v[232:235], v[140:143], v[96:111]
    v_mfma_f32_32x32x16_bf16 v[112:127], v[236:239], v[140:143], v[112:127]
    s_nop 15
    v_cvt_pk_bf16_f32 v32, v64, v65
    v_cvt_pk_bf16_f32 v33, v66, v67
    v_cvt_pk_bf16_f32 v34, v68, v69
    v_cvt_pk_bf16_f32 v35, v70, v71
    v_cvt_pk_bf16_f32 v36, v72, v73
    v_cvt_pk_bf16_f32 v37, v74, v75
    v_cvt_pk_bf16_f32 v38, v76, v77
    v_cvt_pk_bf16_f32 v39, v78, v79
    v_cvt_pk_bf16_f32 v40, v80, v81
    v_cvt_pk_bf16_f32 v41, v82, v83
    v_cvt_pk_bf16_f32 v42, v84, v85
    v_cvt_pk_bf16_f32 v43, v86, v87
    v_cvt_pk_bf16_f32 v44, v88, v89
    v_cvt_pk_bf16_f32 v45, v90, v91
    v_cvt_pk_bf16_f32 v46, v92, v93
    v_cvt_pk_bf16_f32 v47, v94, v95
    v_cvt_pk_bf16_f32 v48, v96, v97
    v_cvt_pk_bf16_f32 v49, v98, v99
    v_cvt_pk_bf16_f32 v50, v100, v101
    v_cvt_pk_bf16_f32 v51, v102, v103
    v_cvt_pk_bf16_f32 v52, v104, v105
    v_cvt_pk_bf16_f32 v53, v106, v107
    v_cvt_pk_bf16_f32 v54, v108, v109
    v_cvt_pk_bf16_f32 v55, v110, v111
    v_cvt_pk_bf16_f32 v56, v112, v113
    v_cvt_pk_bf16_f32 v57, v114, v115
    v_cvt_pk_bf16_f32 v58, v116, v117
    v_cvt_pk_bf16_f32 v59, v118, v119
    v_cvt_pk_bf16_f32 v60, v120, v121
    v_cvt_pk_bf16_f32 v61, v122, v123
    v_cvt_pk_bf16_f32 v62, v124, v125
    v_cvt_pk_bf16_f32 v63, v126, v127
    v_mov_b32 v64, 0
    v_mov_b32 v65, 0
    v_mov_b32 v66, 0
    v_mov_b32 v67, 0
    v_mov_b32 v68, 0
    v_mov_b32 v69, 0
    v_mov_b32 v70, 0
    v_mov_b32 v71, 0
    v_mov_b32 v72, 0
    v_mov_b32 v73, 0
    v_mov_b32 v74, 0
    v_mov_b32 v75, 0
    v_mov_b32 v76, 0
    v_mov_b32 v77, 0
    v_mov_b32 v78, 0
    v_mov_b32 v79, 0
    v_mov_b32 v80, 0
    v_mov_b32 v81, 0
    v_mov_b32 v82, 0
    v_mov_b32 v83, 0
    v_mov_b32 v84, 0
    v_mov_b32 v85, 0
    v_mov_b32 v86, 0
    v_mov_b32 v87, 0
    v_mov_b32 v88, 0
    v_mov_b32 v89, 0
    v_mov_b32 v90, 0
    v_mov_b32 v91, 0
    v_mov_b32 v92, 0
    v_mov_b32 v93, 0
    v_mov_b32 v94, 0
    v_mov_b32 v95, 0
    v_mov_b32 v96, 0
    v_mov_b32 v97, 0
    v_mov_b32 v98, 0
    v_mov_b32 v99, 0
    v_mov_b32 v100, 0
    v_mov_b32 v101, 0
    v_mov_b32 v102, 0
    v_mov_b32 v103, 0
    v_mov_b32 v104, 0
    v_mov_b32 v105, 0
    v_mov_b32 v106, 0
    v_mov_b32 v107, 0
    v_mov_b32 v108, 0
    v_mov_b32 v109, 0
    v_mov_b32 v110, 0
    v_mov_b32 v111, 0
    v_mov_b32 v112, 0
    v_mov_b32 v113, 0
    v_mov_b32 v114, 0
    v_mov_b32 v115, 0
    v_mov_b32 v116, 0
    v_mov_b32 v117, 0
    v_mov_b32 v118, 0
    v_mov_b32 v119, 0
    v_mov_b32 v120, 0
    v_mov_b32 v121, 0
    v_mov_b32 v122, 0
    v_mov_b32 v123, 0
    v_mov_b32 v124, 0
    v_mov_b32 v125, 0
    v_mov_b32 v126, 0
    v_mov_b32 v127, 0
    v_mov_b32 v20, 0xff800000
    v_mov_b32 v22, 0
    v_mov_b32 v26, 0
    v_mov_b32 v21, 0
    s_mov_b32 s33, 7
K1_LOOP:
    s_cmp_lg_u32 s33, 7
    s_cbranch_scc1 K1_P0
    s_setprio 2
K1_P0:
    s_cmp_lg_u32 s33, 4
    s_cbranch_scc1 K1_P1
    s_setprio 1
K1_P1:
    s_cmp_lg_u32 s33, 1
    s_cbranch_scc1 K1_P2
    s_setprio 0
K1_P2:
    s_waitcnt vmcnt(8)
    s_barrier
    ds_read_b128 v[176:179], v8 offset:16384
    ds_read_b128 v[180:183], v9 offset:16384
    ds_read_b128 v[184:187], v10 offset:16384
    ds_read_b128 v[188:191], v11 offset:16384
    ds_read_b128 v[192:195], v12 offset:16384
    ds_read_b128 v[196:199], v13 offset:16384
    ds_read_b128 v[200:203], v14 offset:16384
    ds_read_b128 v[204:207], v15 offset:16384
    ds_read_b128 v[208:211], v8 offset:24576
    ds_read_b128 v[212:215], v9 offset:24576
    ds_read_b128 v[216:219], v10 offset:24576
    ds_read_b128 v[220:223], v11 offset:24576
    ds_read_b128 v[224:227], v12 offset:24576
    s_waitcnt lgkmcnt(12)
    v_mfma_f32_32x32x16_bf16 v[128:143], v[176:179], v[32:35], 0
    ds_read_b128 v[228:231], v13 offset:24576
    s_waitcnt lgkmcnt(12)
    v_mfma_f32_32x32x16_bf16 v[128:143], v[180:183], v[36:39], v[128:143]
    s_add_u32 m0, s30, 0
    s_nop 0
    buffer_load_dwordx4 v5, s[16:19], s32 offen offset:0 nt lds
    ds_read_b128 v[232:235], v14 offset:24576
    s_waitcnt lgkmcnt(12)
    v_mfma_f32_32x32x16_bf16 v[128:143], v[184:187], v[40:43], v[128:143]
    ds_read_b128 v[236:239], v15 offset:24576
    s_waitcnt lgkmcnt(12)
    v_mfma_f32_32x32x16_bf16 v[128:143], v[188:191], v[44:47], v[128:143]
    buffer_load_dwordx4 v5, s[16:19], s32 offen offset:1024 nt lds
    s_waitcnt lgkmcnt(11)
    v_mfma_f32_32x32x16_bf16 v[128:143], v[192:195], v[48:51], v[128:143]
    s_waitcnt lgkmcnt(10)
    v_mfma_f32_32x32x16_bf16 v[128:143], v[196:199], v[52:55], v[128:143]
    buffer_load_dwordx4 v5, s[16:19], s32 offen offset:2048 nt lds
    s_waitcnt lgkmcnt(9)
    v_mfma_f32_32x32x16_bf16 v[128:143], v[200:203], v[56:59], v[128:143]
    s_waitcnt lgkmcnt(8)
    v_mfma_f32_32x32x16_bf16 v[128:143], v[204:207], v[60:63], v[128:143]
    buffer_load_dwordx4 v5, s[16:19], s32 offen offset:3072 nt lds
    s_add_u32 s32, s32, 16384
    s_and_b32 s32, s32, 0x3ffff
    s_waitcnt lgkmcnt(7)
    v_mfma_f32_32x32x16_bf16 v[144:159], v[208:211], v[32:35], 0
    s_waitcnt lgkmcnt(6)
    v_mfma_f32_32x32x16_bf16 v[144:159], v[212:215], v[36:39], v[144:159]
    s_waitcnt lgkmcnt(5)
    v_mfma_f32_32x32x16_bf16 v[144:159], v[216:219], v[40:43], v[144:159]
    s_waitcnt lgkmcnt(4)
    v_mfma_f32_32x32x16_bf16 v[144:159], v[220:223], v[44:47], v[144:159]
    v_max3_f32 v23, v128, v129, v130
    v_max_f32 v23, v23, v131
    s_waitcnt lgkmcnt(3)
    v_mfma_f32_32x32x16_bf16 v[144:159], v[224:227], v[48:51], v[144:159]
    v_max3_f32 v23, v23, v132, v133
    v_max3_f32 v23, v23, v134, v135
    s_waitcnt lgkmcnt(2)
    v_mfma_f32_32x32x16_bf16 v[144:159], v[228:231], v[52:55], v[144:159]
    v_max3_f32 v23, v23, v136, v137
    s_waitcnt lgkmcnt(1)
    v_mfma_f32_32x32x16_bf16 v[144:159], v[232:235], v[56:59], v[144:159]
    v_max3_f32 v23, v23, v138, v139
    v_max3_f32 v23, v23, v140, v141
    s_waitcnt lgkmcnt(0)
    v_mfma_f32_32x32x16_bf16 v[144:159], v[236:239], v[60:63], v[144:159]
    v_max3_f32 v23, v23, v142, v143
    s_waitcnt vmcnt(8)
    s_barrier
    ds_read_b64_tr_b16 v[176:177], v16 offset:32768
    ds_read_b64_tr_b16 v[178:179], v16 offset:33792
    ds_read_b64_tr_b16 v[180:181], v17 offset:32768
    ds_read_b64_tr_b16 v[182:183], v17 offset:33792
    ds_read_b64_tr_b16 v[184:185], v18 offset:32768
    ds_read_b64_tr_b16 v[186:187], v18 offset:33792
    ds_read_b64_tr_b16 v[188:189], v19 offset:32768
    ds_read_b64_tr_b16 v[190:191], v19 offset:33792
    ds_read_b64_tr_b16 v[192:193], v16 offset:36864
    ds_read_b64_tr_b16 v[194:195], v16 offset:37888
    ds_read_b64_tr_b16 v[196:197], v17 offset:36864
    ds_read_b64_tr_b16 v[198:199], v17 offset:37888
    v_max3_f32 v23, v23, v144, v145
    v_max3_f32 v23, v23, v146, v147
    v_max3_f32 v23, v23, v148, v149
    v_max3_f32 v23, v23, v150, v151
    v_max3_f32 v23, v23, v152, v153
    v_max3_f32 v23, v23, v154, v155
    v_max3_f32 v23, v23, v156, v157
    v_max3_f32 v23, v23, v158, v159
    v_mov_b32 v24, v23
    ds_read_b64_tr_b16 v[200:201], v18 offset:36864
    ds_read_b64_tr_b16 v[202:203], v18 offset:37888
    v_permlane32_swap_b32 v23, v24
    ds_read_b64_tr_b16 v[204:205], v19 offset:36864
    ds_read_b64_tr_b16 v[206:207], v19 offset:37888
    v_max_f32 v23, v23, v24
    v_sub_f32 v24, v23, v20
    v_cmp_lt_f32 vcc, s29, v24
    s_cbranch_vccz K1_SKIP1
    v_max_f32 v23, v23, v20
    v_sub_f32 v24, v20, v23
    v_mul_f32 v24, s28, v24
    v_exp_f32 v24, v24
    v_mov_b32 v20, v23
    v_mul_f32 v21, s28, v23
    v_sub_f32 v21, 0, v21
    v_mul_f32 v22, v22, v24
    v_mul_f32 v26, v26, v24
    v_mul_f32 v64, v64, v24
    v_mul_f32 v65, v65, v24
    v_mul_f32 v66, v66, v24
    v_mul_f32 v67, v67, v24
    v_mul_f32 v68, v68, v24
    v_mul_f32 v69, v69, v24
    v_mul_f32 v70, v70, v24
    v_mul_f32 v71, v71, v24
    v_mul_f32 v72, v72, v24
    v_mul_f32 v73, v73, v24
    v_mul_f32 v74, v74, v24
    v_mul_f32 v75, v75, v24
    v_mul_f32 v76, v76, v24
    v_mul_f32 v77, v77, v24
    v_mul_f32 v78, v78, v24
    v_mul_f32 v79, v79, v24
    v_mul_f32 v80, v80, v24
    v_mul_f32 v81, v81, v24
    v_mul_f32 v82, v82, v24
    v_mul_f32 v83, v83, v24
    v_mul_f32 v84, v84, v24
    v_mul_f32 v85, v85, v24
    v_mul_f32 v86, v86, v24
    v_mul_f32 v87, v87, v24
    v_mul_f32 v88, v88, v24
    v_mul_f32 v89, v89, v24
    v_mul_f32 v90, v90, v24
    v_mul_f32 v91, v91, v24
    v_mul_f32 v92, v92, v24
    v_mul_f32 v93, v93, v24
    v_mul_f32 v94, v94, v24
    v_mul_f32 v95, v95, v24
    v_mul_f32 v96, v96, v24
    v_mul_f32 v97, v97, v24
    v_mul_f32 v98, v98, v24
    v_mul_f32 v99, v99, v24
    v_mul_f32 v100, v100, v24
    v_mul_f32 v101, v101, v24
    v_mul_f32 v102, v102, v24
    v_mul_f32 v103, v103, v24
    v_mul_f32 v104, v104, v24
    v_mul_f32 v105, v105, v24
    v_mul_f32 v106, v106, v24
    v_mul_f32 v107, v107, v24
    v_mul_f32 v108, v108, v24
    v_mul_f32 v109, v109, v24
    v_mul_f32 v110, v110, v24
    v_mul_f32 v111, v111, v24
    v_mul_f32 v112, v112, v24
    v_mul_f32 v113, v113, v24
    v_mul_f32 v114, v114, v24
    v_mul_f32 v115, v115, v24
    v_mul_f32 v116, v116, v24
    v_mul_f32 v117, v117, v24
    v_mul_f32 v118, v118, v24
    v_mul_f32 v119, v119, v24
    v_mul_f32 v120, v120, v24
    v_mul_f32 v121, v121, v24
    v_mul_f32 v122, v122, v24
    v_mul_f32 v123, v123, v24
    v_mul_f32 v124, v124, v24
    v_mul_f32 v125, v125, v24
    v_mul_f32 v126, v126, v24
    v_mul_f32 v127, v127, v24
K1_SKIP1:
    v_fma_f32 v128, v128, s28, v21
    ds_read_b64_tr_b16 v[208:209], v16 offset:40960
    v_fma_f32 v129, v129, s28, v21
    v_exp_f32 v128, v128
    ds_read_b64_tr_b16 v[210:211], v16 offset:41984
    v_exp_f32 v129, v129
    v_fma_f32 v130, v130, s28, v21
    ds_read_b64_tr_b16 v[212:213], v17 offset:40960
    v_fma_f32 v131, v131, s28, v21
    v_exp_f32 v130, v130
    ds_read_b64_tr_b16 v[214:215], v17 offset:41984
    v_exp_f32 v131, v131
    v_cvt_pk_bf16_f32 v160, v128, v129
    ds_read_b64_tr_b16 v[216:217], v18 offset:40960
    v_fma_f32 v132, v132, s28, v21
    v_fma_f32 v133, v133, s28, v21
    ds_read_b64_tr_b16 v[218:219], v18 offset:41984
    v_exp_f32 v132, v132
    v_exp_f32 v133, v133
    ds_read_b64_tr_b16 v[220:221], v19 offset:40960
    v_cvt_pk_bf16_f32 v161, v130, v131
    v_fma_f32 v134, v134, s28, v21
    ds_read_b64_tr_b16 v[222:223], v19 offset:41984
    v_fma_f32 v135, v135, s28, v21
    v_exp_f32 v134, v134
    ds_read_b64_tr_b16 v[224:225], v16 offset:45056
    v_exp_f32 v135, v135
    v_cvt_pk_bf16_f32 v162, v132, v133
    ds_read_b64_tr_b16 v[226:227], v16 offset:46080
    v_fma_f32 v136, v136, s28, v21
    v_fma_f32 v137, v137, s28, v21
    ds_read_b64_tr_b16 v[228:229], v17 offset:45056
    v_exp_f32 v136, v136
    v_exp_f32 v137, v137
    ds_read_b64_tr_b16 v[230:231], v17 offset:46080
    v_cvt_pk_bf16_f32 v163, v134, v135
    v_fma_f32 v138, v138, s28, v21
    ds_read_b64_tr_b16 v[232:233], v18 offset:45056
    v_fma_f32 v139, v139, s28, v21
    v_exp_f32 v138, v138
    ds_read_b64_tr_b16 v[234:235], v18 offset:46080
    v_exp_f32 v139, v139
    v_cvt_pk_bf16_f32 v164, v136, v137
    ds_read_b64_tr_b16 v[236:237], v19 offset:45056
    v_fma_f32 v140, v140, s28, v21
    v_fma_f32 v141, v141, s28, v21
    ds_read_b64_tr_b16 v[238:239], v19 offset:46080
    v_exp_f32 v140, v140
    v_exp_f32 v141, v141
    v_cvt_pk_bf16_f32 v165, v138, v139
    v_fma_f32 v142, v142, s28, v21
    v_fma_f32 v143, v143, s28, v21
    v_exp_f32 v142, v142
    v_exp_f32 v143, v143
    v_cvt_pk_bf16_f32 v166, v140, v141
    s_nop 0
    v_cvt_pk_bf16_f32 v167, v142, v143
    s_waitcnt lgkmcnt(15)
    s_nop 0
    v_mfma_f32_32x32x16_bf16 v[64:79], v[176:179], v[160:163], v[64:79]
    s_add_u32 m0, s30, 16384
    s_nop 0
    buffer_load_dwordx4 v1, s[12:15], s31 offen offset:0 nt lds
    v_fma_f32 v144, v144, s28, v21
    v_fma_f32 v145, v145, s28, v21
    v_exp_f32 v144, v144
    v_exp_f32 v145, v145
    v_fma_f32 v146, v146, s28, v21
    v_fma_f32 v147, v147, s28, v21
    v_mfma_f32_32x32x16_bf16 v[80:95], v[180:183], v[160:163], v[80:95]
    v_exp_f32 v146, v146
    v_exp_f32 v147, v147
    v_cvt_pk_bf16_f32 v168, v144, v145
    v_fma_f32 v148, v148, s28, v21
    v_fma_f32 v149, v149, s28, v21
    v_mfma_f32_32x32x16_bf16 v[96:111], v[184:187], v[160:163], v[96:111]
    buffer_load_dwordx4 v2, s[12:15], s31 offen offset:1024 nt lds
    v_exp_f32 v148, v148
    v_exp_f32 v149, v149
    v_cvt_pk_bf16_f32 v169, v146, v147
    v_fma_f32 v150, v150, s28, v21
    v_fma_f32 v151, v151, s28, v21
    v_mfma_f32_32x32x16_bf16 v[112:127], v[188:191], v[160:163], v[112:127]
    v_exp_f32 v150, v150
    v_exp_f32 v151, v151
    v_cvt_pk_bf16_f32 v170, v148, v149
    v_fma_f32 v152, v152, s28, v21
    v_fma_f32 v153, v153, s28, v21
    v_mfma_f32_32x32x16_bf16 v[64:79], v[192:195], v[164:167], v[64:79]
    buffer_load_dwordx4 v3, s[12:15], s31 offen offset:2048 nt lds
    v_exp_f32 v152, v152
    v_exp_f32 v153, v153
    v_cvt_pk_bf16_f32 v171, v150, v151
    v_fma_f32 v154, v154, s28, v21
    v_fma_f32 v155, v155, s28, v21
    v_mfma_f32_32x32x16_bf16 v[80:95], v[196:199], v[164:167], v[80:95]
    v_exp_f32 v154, v154
    v_exp_f32 v155, v155
    v_cvt_pk_bf16_f32 v172, v152, v153
    v_fma_f32 v156, v156, s28, v21
    v_fma_f32 v157, v157, s28, v21
    v_mfma_f32_32x32x16_bf16 v[96:111], v[200:203], v[164:167], v[96:111]
    buffer_load_dwordx4 v4, s[12:15], s31 offen offset:3072 nt lds
    s_add_u32 s31, s31, 16384
    s_and_b32 s31, s31, 0x3ffff
    v_exp_f32 v156, v156
    v_exp_f32 v157, v157
    v_cvt_pk_bf16_f32 v173, v154, v155
    v_fma_f32 v158, v158, s28, v21
    v_fma_f32 v159, v159, s28, v21
    v_mfma_f32_32x32x16_bf16 v[112:127], v[204:207], v[164:167], v[112:127]
    v_exp_f32 v158, v158
    v_exp_f32 v159, v159
    v_cvt_pk_bf16_f32 v174, v156, v157
    s_nop 0
    v_cvt_pk_bf16_f32 v175, v158, v159
    s_waitcnt lgkmcnt(0)
    s_nop 0
    v_mfma_f32_32x32x16_bf16 v[64:79], v[208:211], v[168:171], v[64:79]
    v_add_f32 v26, v26, v128
    v_add_f32 v22, v22, v129
    v_add_f32 v26, v26, v130
    v_add_f32 v22, v22, v131
    v_mfma_f32_32x32x16_bf16 v[80:95], v[212:215], v[168:171], v[80:95]
    v_add_f32 v26, v26, v132
    v_add_f32 v22, v22, v133
    v_add_f32 v26, v26, v134
    v_add_f32 v22, v22, v135
    v_mfma_f32_32x32x16_bf16 v[96:111], v[216:219], v[168:171], v[96:111]
    v_add_f32 v26, v26, v136
    v_add_f32 v22, v22, v137
    v_add_f32 v26, v26, v138
    v_add_f32 v22, v22, v139
    v_mfma_f32_32x32x16_bf16 v[112:127], v[220:223], v[168:171], v[112:127]
    v_add_f32 v26, v26, v140
    v_add_f32 v22, v22, v141
    v_add_f32 v26, v26, v142
    v_add_f32 v22, v22, v143
    v_mfma_f32_32x32x16_bf16 v[64:79], v[224:227], v[172:175], v[64:79]
    v_add_f32 v26, v26, v144
    v_add_f32 v22, v22, v145
    v_add_f32 v26, v26, v146
    v_add_f32 v22, v22, v147
    v_mfma_f32_32x32x16_bf16 v[80:95], v[228:231], v[172:175], v[80:95]
    v_add_f32 v26, v26, v148
    v_add_f32 v22, v22, v149
    v_add_f32 v26, v26, v150
    v_add_f32 v22, v22, v151
    v_mfma_f32_32x32x16_bf16 v[96:111], v[232:235], v[172:175], v[96:111]
    v_add_f32 v26, v26, v152
    v_add_f32 v22, v22, v153
    v_add_f32 v26, v26, v154
    v_add_f32 v22, v22, v155
    v_mfma_f32_32x32x16_bf16 v[112:127], v[236:239], v[172:175], v[112:127]
    v_add_f32 v26, v26, v156
    v_add_f32 v22, v22, v157
    v_add_f32 v26, v26, v158
    v_add_f32 v22, v22, v159
    s_waitcnt vmcnt(8)
    s_barrier
    ds_read_b128 v[176:179], v8 offset:49152
    ds_read_b128 v[180:183], v9 offset:49152
    ds_read_b128 v[184:187], v10 offset:49152
    ds_read_b128 v[188:191], v11 offset:49152
    ds_read_b128 v[192:195], v12 offset:49152
    ds_read_b128 v[196:199], v13 offset:49152
    ds_read_b128 v[200:203], v14 offset:49152
    ds_read_b128 v[204:207], v15 offset:49152
    ds_read_b128 v[208:211], v8 offset:57344
    ds_read_b128 v[212:215], v9 offset:57344
    ds_read_b128 v[216:219], v10 offset:57344
    ds_read_b128 v[220:223], v11 offset:57344
    ds_read_b128 v[224:227], v12 offset:57344
    s_waitcnt lgkmcnt(12)
    v_mfma_f32_32x32x16_bf16 v[128:143], v[176:179], v[32:35], 0
    ds_read_b128 v[228:231], v13 offset:57344
    s_waitcnt lgkmcnt(12)
    v_mfma_f32_32x32x16_bf16 v[128:143], v[180:183], v[36:39], v[128:143]
    s_add_u32 m0, s30, 32768
    s_nop 0
    buffer_load_dwordx4 v5, s[16:19], s32 offen offset:0 nt lds
    ds_read_b128 v[232:235], v14 offset:57344
    s_waitcnt lgkmcnt(12)
    v_mfma_f32_32x32x16_bf16 v[128:143], v[184:187], v[40:43], v[128:143]
    ds_read_b128 v[236:239], v15 offset:57344
    s_waitcnt lgkmcnt(12)
    v_mfma_f32_32x32x16_bf16 v[128:143], v[188:191], v[44:47], v[128:143]
    buffer_load_dwordx4 v5, s[16:19], s32 offen offset:1024 nt lds
    s_waitcnt lgkmcnt(11)
    v_mfma_f32_32x32x16_bf16 v[128:143], v[192:195], v[48:51], v[128:143]
    s_waitcnt lgkmcnt(10)
    v_mfma_f32_32x32x16_bf16 v[128:143], v[196:199], v[52:55], v[128:143]
    buffer_load_dwordx4 v5, s[16:19], s32 offen offset:2048 nt lds
    s_waitcnt lgkmcnt(9)
    v_mfma_f32_32x32x16_bf16 v[128:143], v[200:203], v[56:59], v[128:143]
    s_waitcnt lgkmcnt(8)
    v_mfma_f32_32x32x16_bf16 v[128:143], v[204:207], v[60:63], v[128:143]
    buffer_load_dwordx4 v5, s[16:19], s32 offen offset:3072 nt lds
    s_add_u32 s32, s32, 16384
    s_and_b32 s32, s32, 0x3ffff
    s_waitcnt lgkmcnt(7)
    v_mfma_f32_32x32x16_bf16 v[144:159], v[208:211], v[32:35], 0
    s_waitcnt lgkmcnt(6)
    v_mfma_f32_32x32x16_bf16 v[144:159], v[212:215], v[36:39], v[144:159]
    s_waitcnt lgkmcnt(5)
    v_mfma_f32_32x32x16_bf16 v[144:159], v[216:219], v[40:43], v[144:159]
    s_waitcnt lgkmcnt(4)
    v_mfma_f32_32x32x16_bf16 v[144:159], v[220:223], v[44:47], v[144:159]
    v_max3_f32 v23, v128, v129, v130
    v_max_f32 v23, v23, v131
    s_waitcnt lgkmcnt(3)
    v_mfma_f32_32x32x16_bf16 v[144:159], v[224:227], v[48:51], v[144:159]
    v_max3_f32 v23, v23, v132, v133
    v_max3_f32 v23, v23, v134, v135
    s_waitcnt lgkmcnt(2)
    v_mfma_f32_32x32x16_bf16 v[144:159], v[228:231], v[52:55], v[144:159]
    v_max3_f32 v23, v23, v136, v137
    s_waitcnt lgkmcnt(1)
    v_mfma_f32_32x32x16_bf16 v[144:159], v[232:235], v[56:59], v[144:159]
    v_max3_f32 v23, v23, v138, v139
    v_max3_f32 v23, v23, v140, v141
    s_waitcnt lgkmcnt(0)
    v_mfma_f32_32x32x16_bf16 v[144:159], v[236:239], v[60:63], v[144:159]
    v_max3_f32 v23, v23, v142, v143
    s_waitcnt vmcnt(8)
    s_barrier
    ds_read_b64_tr_b16 v[176:177], v16 offset:0
    ds_read_b64_tr_b16 v[178:179], v16 offset:1024
    ds_read_b64_tr_b16 v[180:181], v17 offset:0
    ds_read_b64_tr_b16 v[182:183], v17 offset:1024
    ds_read_b64_tr_b16 v[184:185], v18 offset:0
    ds_read_b64_tr_b16 v[186:187], v18 offset:1024
    ds_read_b64_tr_b16 v[188:189], v19 offset:0
    ds_read_b64_tr_b16 v[190:191], v19 offset:1024
    ds_read_b64_tr_b16 v[192:193], v16 offset:4096
    ds_read_b64_tr_b16 v[194:195], v16 offset:5120
    ds_read_b64_tr_b16 v[196:197], v17 offset:4096
    ds_read_b64_tr_b16 v[198:199], v17 offset:5120
    v_max3_f32 v23, v23, v144, v145
    v_max3_f32 v23, v23, v146, v147
    v_max3_f32 v23, v23, v148, v149
    v_max3_f32 v23, v23, v150, v151
    v_max3_f32 v23, v23, v152, v153
    v_max3_f32 v23, v23, v154, v155
    v_max3_f32 v23, v23, v156, v157
    v_max3_f32 v23, v23, v158, v159
    v_mov_b32 v24, v23
    ds_read_b64_tr_b16 v[200:201], v18 offset:4096
    ds_read_b64_tr_b16 v[202:203], v18 offset:5120
    v_permlane32_swap_b32 v23, v24
    ds_read_b64_tr_b16 v[204:205], v19 offset:4096
    ds_read_b64_tr_b16 v[206:207], v19 offset:5120
    v_max_f32 v23, v23, v24
    v_sub_f32 v24, v23, v20
    v_cmp_lt_f32 vcc, s29, v24
    s_cbranch_vccz K1_SKIP2
    v_max_f32 v23, v23, v20
    v_sub_f32 v24, v20, v23
    v_mul_f32 v24, s28, v24
    v_exp_f32 v24, v24
    v_mov_b32 v20, v23
    v_mul_f32 v21, s28, v23
    v_sub_f32 v21, 0, v21
    v_mul_f32 v22, v22, v24
    v_mul_f32 v26, v26, v24
    v_mul_f32 v64, v64, v24
    v_mul_f32 v65, v65, v24
    v_mul_f32 v66, v66, v24
    v_mul_f32 v67, v67, v24
    v_mul_f32 v68, v68, v24
    v_mul_f32 v69, v69, v24
    v_mul_f32 v70, v70, v24
    v_mul_f32 v71, v71, v24
    v_mul_f32 v72, v72, v24
    v_mul_f32 v73, v73, v24
    v_mul_f32 v74, v74, v24
    v_mul_f32 v75, v75, v24
    v_mul_f32 v76, v76, v24
    v_mul_f32 v77, v77, v24
    v_mul_f32 v78, v78, v24
    v_mul_f32 v79, v79, v24
    v_mul_f32 v80, v80, v24
    v_mul_f32 v81, v81, v24
    v_mul_f32 v82, v82, v24
    v_mul_f32 v83, v83, v24
    v_mul_f32 v84, v84, v24
    v_mul_f32 v85, v85, v24
    v_mul_f32 v86, v86, v24
    v_mul_f32 v87, v87, v24
    v_mul_f32 v88, v88, v24
    v_mul_f32 v89, v89, v24
    v_mul_f32 v90, v90, v24
    v_mul_f32 v91, v91, v24
    v_mul_f32 v92, v92, v24
    v_mul_f32 v93, v93, v24
    v_mul_f32 v94, v94, v24
    v_mul_f32 v95, v95, v24
    v_mul_f32 v96, v96, v24
    v_mul_f32 v97, v97, v24
    v_mul_f32 v98, v98, v24
    v_mul_f32 v99, v99, v24
    v_mul_f32 v100, v100, v24
    v_mul_f32 v101, v101, v24
    v_mul_f32 v102, v102, v24
    v_mul_f32 v103, v103, v24
    v_mul_f32 v104, v104, v24
    v_mul_f32 v105, v105, v24
    v_mul_f32 v106, v106, v24
    v_mul_f32 v107, v107, v24
    v_mul_f32 v108, v108, v24
    v_mul_f32 v109, v109, v24
    v_mul_f32 v110, v110, v24
    v_mul_f32 v111, v111, v24
    v_mul_f32 v112, v112, v24
    v_mul_f32 v113, v113, v24
    v_mul_f32 v114, v114, v24
    v_mul_f32 v115, v115, v24
    v_mul_f32 v116, v116, v24
    v_mul_f32 v117, v117, v24
    v_mul_f32 v118, v118, v24
    v_mul_f32 v119, v119, v24
    v_mul_f32 v120, v120, v24
    v_mul_f32 v121, v121, v24
    v_mul_f32 v122, v122, v24
    v_mul_f32 v123, v123, v24
    v_mul_f32 v124, v124, v24
    v_mul_f32 v125, v125, v24
    v_mul_f32 v126, v126, v24
    v_mul_f32 v127, v127, v24
K1_SKIP2:
    v_fma_f32 v128, v128, s28, v21
    ds_read_b64_tr_b16 v[208:209], v16 offset:8192
    v_fma_f32 v129, v129, s28, v21
    v_exp_f32 v128, v128
    ds_read_b64_tr_b16 v[210:211], v16 offset:9216
    v_exp_f32 v129, v129
    v_fma_f32 v130, v130, s28, v21
    ds_read_b64_tr_b16 v[212:213], v17 offset:8192
    v_fma_f32 v131, v131, s28, v21
    v_exp_f32 v130, v130
    ds_read_b64_tr_b16 v[214:215], v17 offset:9216
    v_exp_f32 v131, v131
    v_cvt_pk_bf16_f32 v160, v128, v129
    ds_read_b64_tr_b16 v[216:217], v18 offset:8192
    v_fma_f32 v132, v132, s28, v21
    v_fma_f32 v133, v133, s28, v21
    ds_read_b64_tr_b16 v[218:219], v18 offset:9216
    v_exp_f32 v132, v132
    v_exp_f32 v133, v133
    ds_read_b64_tr_b16 v[220:221], v19 offset:8192
    v_cvt_pk_bf16_f32 v161, v130, v131
    v_fma_f32 v134, v134, s28, v21
    ds_read_b64_tr_b16 v[222:223], v19 offset:9216
    v_fma_f32 v135, v135, s28, v21
    v_exp_f32 v134, v134
    ds_read_b64_tr_b16 v[224:225], v16 offset:12288
    v_exp_f32 v135, v135
    v_cvt_pk_bf16_f32 v162, v132, v133
    ds_read_b64_tr_b16 v[226:227], v16 offset:13312
    v_fma_f32 v136, v136, s28, v21
    v_fma_f32 v137, v137, s28, v21
    ds_read_b64_tr_b16 v[228:229], v17 offset:12288
    v_exp_f32 v136, v136
    v_exp_f32 v137, v137
    ds_read_b64_tr_b16 v[230:231], v17 offset:13312
    v_cvt_pk_bf16_f32 v163, v134, v135
    v_fma_f32 v138, v138, s28, v21
    ds_read_b64_tr_b16 v[232:233], v18 offset:12288
    v_fma_f32 v139, v139, s28, v21
    v_exp_f32 v138, v138
    ds_read_b64_tr_b16 v[234:235], v18 offset:13312
    v_exp_f32 v139, v139
    v_cvt_pk_bf16_f32 v164, v136, v137
    ds_read_b64_tr_b16 v[236:237], v19 offset:12288
    v_fma_f32 v140, v140, s28, v21
    v_fma_f32 v141, v141, s28, v21
    ds_read_b64_tr_b16 v[238:239], v19 offset:13312
    v_exp_f32 v140, v140
    v_exp_f32 v141, v141
    v_cvt_pk_bf16_f32 v165, v138, v139
    v_fma_f32 v142, v142, s28, v21
    v_fma_f32 v143, v143, s28, v21
    v_exp_f32 v142, v142
    v_exp_f32 v143, v143
    v_cvt_pk_bf16_f32 v166, v140, v141
    s_nop 0
    v_cvt_pk_bf16_f32 v167, v142, v143
    s_waitcnt lgkmcnt(15)
    s_nop 0
    v_mfma_f32_32x32x16_bf16 v[64:79], v[176:179], v[160:163], v[64:79]
    s_add_u32 m0, s30, 49152
    s_nop 0
    buffer_load_dwordx4 v1, s[12:15], s31 offen offset:0 nt lds
    v_fma_f32 v144, v144, s28, v21
    v_fma_f32 v145, v145, s28, v21
    v_exp_f32 v144, v144
    v_exp_f32 v145, v145
    v_fma_f32 v146, v146, s28, v21
    v_fma_f32 v147, v147, s28, v21
    v_mfma_f32_32x32x16_bf16 v[80:95], v[180:183], v[160:163], v[80:95]
    v_exp_f32 v146, v146
    v_exp_f32 v147, v147
    v_cvt_pk_bf16_f32 v168, v144, v145
    v_fma_f32 v148, v148, s28, v21
    v_fma_f32 v149, v149, s28, v21
    v_mfma_f32_32x32x16_bf16 v[96:111], v[184:187], v[160:163], v[96:111]
    buffer_load_dwordx4 v2, s[12:15], s31 offen offset:1024 nt lds
    v_exp_f32 v148, v148
    v_exp_f32 v149, v149
    v_cvt_pk_bf16_f32 v169, v146, v147
    v_fma_f32 v150, v150, s28, v21
    v_fma_f32 v151, v151, s28, v21
    v_mfma_f32_32x32x16_bf16 v[112:127], v[188:191], v[160:163], v[112:127]
    v_exp_f32 v150, v150
    v_exp_f32 v151, v151
    v_cvt_pk_bf16_f32 v170, v148, v149
    v_fma_f32 v152, v152, s28, v21
    v_fma_f32 v153, v153, s28, v21
    v_mfma_f32_32x32x16_bf16 v[64:79], v[192:195], v[164:167], v[64:79]
    buffer_load_dwordx4 v3, s[12:15], s31 offen offset:2048 nt lds
    v_exp_f32 v152, v152
    v_exp_f32 v153, v153
    v_cvt_pk_bf16_f32 v171, v150, v151
    v_fma_f32 v154, v154, s28, v21
    v_fma_f32 v155, v155, s28, v21
    v_mfma_f32_32x32x16_bf16 v[80:95], v[196:199], v[164:167], v[80:95]
    v_exp_f32 v154, v154
    v_exp_f32 v155, v155
    v_cvt_pk_bf16_f32 v172, v152, v153
    v_fma_f32 v156, v156, s28, v21
    v_fma_f32 v157, v157, s28, v21
    v_mfma_f32_32x32x16_bf16 v[96:111], v[200:203], v[164:167], v[96:111]
    buffer_load_dwordx4 v4, s[12:15], s31 offen offset:3072 nt lds
    s_add_u32 s31, s31, 16384
    s_and_b32 s31, s31, 0x3ffff
    v_exp_f32 v156, v156
    v_exp_f32 v157, v157
    v_cvt_pk_bf16_f32 v173, v154, v155
    v_fma_f32 v158, v158, s28, v21
    v_fma_f32 v159, v159, s28, v21
    v_mfma_f32_32x32x16_bf16 v[112:127], v[204:207], v[164:167], v[112:127]
    v_exp_f32 v158, v158
    v_exp_f32 v159, v159
    v_cvt_pk_bf16_f32 v174, v156, v157
    s_nop 0
    v_cvt_pk_bf16_f32 v175, v158, v159
    s_waitcnt lgkmcnt(0)
    s_nop 0
    v_mfma_f32_32x32x16_bf16 v[64:79], v[208:211], v[168:171], v[64:79]
    v_add_f32 v26, v26, v128
    v_add_f32 v22, v22, v129
    v_add_f32 v26, v26, v130
    v_add_f32 v22, v22, v131
    v_mfma_f32_32x32x16_bf16 v[80:95], v[212:215], v[168:171], v[80:95]
    v_add_f32 v26, v26, v132
    v_add_f32 v22, v22, v133
    v_add_f32 v26, v26, v134
    v_add_f32 v22, v22, v135
    v_mfma_f32_32x32x16_bf16 v[96:111], v[216:219], v[168:171], v[96:111]
    v_add_f32 v26, v26, v136
    v_add_f32 v22, v22, v137
    v_add_f32 v26, v26, v138
    v_add_f32 v22, v22, v139
    v_mfma_f32_32x32x16_bf16 v[112:127], v[220:223], v[168:171], v[112:127]
    v_add_f32 v26, v26, v140
    v_add_f32 v22, v22, v141
    v_add_f32 v26, v26, v142
    v_add_f32 v22, v22, v143
    v_mfma_f32_32x32x16_bf16 v[64:79], v[224:227], v[172:175], v[64:79]
    v_add_f32 v26, v26, v144
    v_add_f32 v22, v22, v145
    v_add_f32 v26, v26, v146
    v_add_f32 v22, v22, v147
    v_mfma_f32_32x32x16_bf16 v[80:95], v[228:231], v[172:175], v[80:95]
    v_add_f32 v26, v26, v148
    v_add_f32 v22, v22, v149
    v_add_f32 v26, v26, v150
    v_add_f32 v22, v22, v151
    v_mfma_f32_32x32x16_bf16 v[96:111], v[232:235], v[172:175], v[96:111]
    v_add_f32 v26, v26, v152
    v_add_f32 v22, v22, v153
    v_add_f32 v26, v26, v154
    v_add_f32 v22, v22, v155
    v_mfma_f32_32x32x16_bf16 v[112:127], v[236:239], v[172:175], v[112:127]
    v_add_f32 v26, v26, v156
    v_add_f32 v22, v22, v157
    v_add_f32 v26, v26, v158
    v_add_f32 v22, v22, v159
    s_sub_u32 s33, s33, 1
    s_cmp_lg_u32 s33, 0
    s_cbranch_scc1 K1_LOOP
    s_waitcnt vmcnt(8)
    s_barrier
    ds_read_b128 v[176:179], v8 offset:16384
    ds_read_b128 v[180:183], v9 offset:16384
    ds_read_b128 v[184:187], v10 offset:16384
    ds_read_b128 v[188:191], v11 offset:16384
    ds_read_b128 v[192:195], v12 offset:16384
    ds_read_b128 v[196:199], v13 offset:16384
    ds_read_b128 v[200:203], v14 offset:16384
    ds_read_b128 v[204:207], v15 offset:16384
    ds_read_b128 v[208:211], v8 offset:24576
    ds_read_b128 v[212:215], v9 offset:24576
    ds_read_b128 v[216:219], v10 offset:24576
    ds_read_b128 v[220:223], v11 offset:24576
    ds_read_b128 v[224:227], v12 offset:24576
    s_waitcnt lgkmcnt(12)
    v_mfma_f32_32x32x16_bf16 v[128:143], v[176:179], v[32:35], 0
    ds_read_b128 v[228:231], v13 offset:24576
    s_waitcnt lgkmcnt(12)
    v_mfma_f32_32x32x16_bf16 v[128:143], v[180:183], v[36:39], v[128:143]
    s_add_u32 m0, s30, 0
    s_nop 0
    buffer_load_dwordx4 v5, s[16:19], s32 offen offset:0 nt lds
    ds_read_b128 v[232:235], v14 offset:24576
    s_waitcnt lgkmcnt(12)
    v_mfma_f32_32x32x16_bf16 v[128:143], v[184:187], v[40:43], v[128:143]
    ds_read_b128 v[236:239], v15 offset:24576
    s_waitcnt lgkmcnt(12)
    v_mfma_f32_32x32x16_bf16 v[128:143], v[188:191], v[44:47], v[128:143]
    buffer_load_dwordx4 v5, s[16:19], s32 offen offset:1024 nt lds
    s_waitcnt lgkmcnt(11)
    v_mfma_f32_32x32x16_bf16 v[128:143], v[192:195], v[48:51], v[128:143]
    s_waitcnt lgkmcnt(10)
    v_mfma_f32_32x32x16_bf16 v[128:143], v[196:199], v[52:55], v[128:143]
    buffer_load_dwordx4 v5, s[16:19], s32 offen offset:2048 nt lds
    s_waitcnt lgkmcnt(9)
    v_mfma_f32_32x32x16_bf16 v[128:143], v[200:203], v[56:59], v[128:143]
    s_waitcnt lgkmcnt(8)
    v_mfma_f32_32x32x16_bf16 v[128:143], v[204:207], v[60:63], v[128:143]
    buffer_load_dwordx4 v5, s[16:19], s32 offen offset:3072 nt lds
    s_add_u32 s32, s32, 16384
    s_and_b32 s32, s32, 0x3ffff
    s_waitcnt lgkmcnt(7)
    v_mfma_f32_32x32x16_bf16 v[144:159], v[208:211], v[32:35], 0
    s_waitcnt lgkmcnt(6)
    v_mfma_f32_32x32x16_bf16 v[144:159], v[212:215], v[36:39], v[144:159]
    s_waitcnt lgkmcnt(5)
    v_mfma_f32_32x32x16_bf16 v[144:159], v[216:219], v[40:43], v[144:159]
    s_waitcnt lgkmcnt(4)
    v_mfma_f32_32x32x16_bf16 v[144:159], v[220:223], v[44:47], v[144:159]
    v_max3_f32 v23, v128, v129, v130
    v_max_f32 v23, v23, v131
    s_waitcnt lgkmcnt(3)
    v_mfma_f32_32x32x16_bf16 v[144:159], v[224:227], v[48:51], v[144:159]
    v_max3_f32 v23, v23, v132, v133
    v_max3_f32 v23, v23, v134, v135
    s_waitcnt lgkmcnt(2)
    v_mfma_f32_32x32x16_bf16 v[144:159], v[228:231], v[52:55], v[144:159]
    v_max3_f32 v23, v23, v136, v137
    s_waitcnt lgkmcnt(1)
    v_mfma_f32_32x32x16_bf16 v[144:159], v[232:235], v[56:59], v[144:159]
    v_max3_f32 v23, v23, v138, v139
    v_max3_f32 v23, v23, v140, v141
    s_waitcnt lgkmcnt(0)
    v_mfma_f32_32x32x16_bf16 v[144:159], v[236:239], v[60:63], v[144:159]
    v_max3_f32 v23, v23, v142, v143
    s_waitcnt vmcnt(8)
    s_barrier
    ds_read_b64_tr_b16 v[176:177], v16 offset:32768
    ds_read_b64_tr_b16 v[178:179], v16 offset:33792
    ds_read_b64_tr_b16 v[180:181], v17 offset:32768
    ds_read_b64_tr_b16 v[182:183], v17 offset:33792
    ds_read_b64_tr_b16 v[184:185], v18 offset:32768
    ds_read_b64_tr_b16 v[186:187], v18 offset:33792
    ds_read_b64_tr_b16 v[188:189], v19 offset:32768
    ds_read_b64_tr_b16 v[190:191], v19 offset:33792
    ds_read_b64_tr_b16 v[192:193], v16 offset:36864
    ds_read_b64_tr_b16 v[194:195], v16 offset:37888
    ds_read_b64_tr_b16 v[196:197], v17 offset:36864
    ds_read_b64_tr_b16 v[198:199], v17 offset:37888
    v_max3_f32 v23, v23, v144, v145
    v_max3_f32 v23, v23, v146, v147
    v_max3_f32 v23, v23, v148, v149
    v_max3_f32 v23, v23, v150, v151
    v_max3_f32 v23, v23, v152, v153
    v_max3_f32 v23, v23, v154, v155
    v_max3_f32 v23, v23, v156, v157
    v_max3_f32 v23, v23, v158, v159
    v_mov_b32 v24, v23
    ds_read_b64_tr_b16 v[200:201], v18 offset:36864
    ds_read_b64_tr_b16 v[202:203], v18 offset:37888
    v_permlane32_swap_b32 v23, v24
    ds_read_b64_tr_b16 v[204:205], v19 offset:36864
    ds_read_b64_tr_b16 v[206:207], v19 offset:37888
    v_max_f32 v23, v23, v24
    v_sub_f32 v24, v23, v20
    v_cmp_lt_f32 vcc, s29, v24
    s_cbranch_vccz K1_SKIP3
    v_max_f32 v23, v23, v20
    v_sub_f32 v24, v20, v23
    v_mul_f32 v24, s28, v24
    v_exp_f32 v24, v24
    v_mov_b32 v20, v23
    v_mul_f32 v21, s28, v23
    v_sub_f32 v21, 0, v21
    v_mul_f32 v22, v22, v24
    v_mul_f32 v26, v26, v24
    v_mul_f32 v64, v64, v24
    v_mul_f32 v65, v65, v24
    v_mul_f32 v66, v66, v24
    v_mul_f32 v67, v67, v24
    v_mul_f32 v68, v68, v24
    v_mul_f32 v69, v69, v24
    v_mul_f32 v70, v70, v24
    v_mul_f32 v71, v71, v24
    v_mul_f32 v72, v72, v24
    v_mul_f32 v73, v73, v24
    v_mul_f32 v74, v74, v24
    v_mul_f32 v75, v75, v24
    v_mul_f32 v76, v76, v24
    v_mul_f32 v77, v77, v24
    v_mul_f32 v78, v78, v24
    v_mul_f32 v79, v79, v24
    v_mul_f32 v80, v80, v24
    v_mul_f32 v81, v81, v24
    v_mul_f32 v82, v82, v24
    v_mul_f32 v83, v83, v24
    v_mul_f32 v84, v84, v24
    v_mul_f32 v85, v85, v24
    v_mul_f32 v86, v86, v24
    v_mul_f32 v87, v87, v24
    v_mul_f32 v88, v88, v24
    v_mul_f32 v89, v89, v24
    v_mul_f32 v90, v90, v24
    v_mul_f32 v91, v91, v24
    v_mul_f32 v92, v92, v24
    v_mul_f32 v93, v93, v24
    v_mul_f32 v94, v94, v24
    v_mul_f32 v95, v95, v24
    v_mul_f32 v96, v96, v24
    v_mul_f32 v97, v97, v24
    v_mul_f32 v98, v98, v24
    v_mul_f32 v99, v99, v24
    v_mul_f32 v100, v100, v24
    v_mul_f32 v101, v101, v24
    v_mul_f32 v102, v102, v24
    v_mul_f32 v103, v103, v24
    v_mul_f32 v104, v104, v24
    v_mul_f32 v105, v105, v24
    v_mul_f32 v106, v106, v24
    v_mul_f32 v107, v107, v24
    v_mul_f32 v108, v108, v24
    v_mul_f32 v109, v109, v24
    v_mul_f32 v110, v110, v24
    v_mul_f32 v111, v111, v24
    v_mul_f32 v112, v112, v24
    v_mul_f32 v113, v113, v24
    v_mul_f32 v114, v114, v24
    v_mul_f32 v115, v115, v24
    v_mul_f32 v116, v116, v24
    v_mul_f32 v117, v117, v24
    v_mul_f32 v118, v118, v24
    v_mul_f32 v119, v119, v24
    v_mul_f32 v120, v120, v24
    v_mul_f32 v121, v121, v24
    v_mul_f32 v122, v122, v24
    v_mul_f32 v123, v123, v24
    v_mul_f32 v124, v124, v24
    v_mul_f32 v125, v125, v24
    v_mul_f32 v126, v126, v24
    v_mul_f32 v127, v127, v24
K1_SKIP3:
    v_fma_f32 v128, v128, s28, v21
    ds_read_b64_tr_b16 v[208:209], v16 offset:40960
    v_fma_f32 v129, v129, s28, v21
    v_exp_f32 v128, v128
    ds_read_b64_tr_b16 v[210:211], v16 offset:41984
    v_exp_f32 v129, v129
    v_fma_f32 v130, v130, s28, v21
    ds_read_b64_tr_b16 v[212:213], v17 offset:40960
    v_fma_f32 v131, v131, s28, v21
    v_exp_f32 v130, v130
    ds_read_b64_tr_b16 v[214:215], v17 offset:41984
    v_exp_f32 v131, v131
    v_cvt_pk_bf16_f32 v160, v128, v129
    ds_read_b64_tr_b16 v[216:217], v18 offset:40960
    v_fma_f32 v132, v132, s28, v21
    v_fma_f32 v133, v133, s28, v21
    ds_read_b64_tr_b16 v[218:219], v18 offset:41984
    v_exp_f32 v132, v132
    v_exp_f32 v133, v133
    ds_read_b64_tr_b16 v[220:221], v19 offset:40960
    v_cvt_pk_bf16_f32 v161, v130, v131
    v_fma_f32 v134, v134, s28, v21
    ds_read_b64_tr_b16 v[222:223], v19 offset:41984
    v_fma_f32 v135, v135, s28, v21
    v_exp_f32 v134, v134
    ds_read_b64_tr_b16 v[224:225], v16 offset:45056
    v_exp_f32 v135, v135
    v_cvt_pk_bf16_f32 v162, v132, v133
    ds_read_b64_tr_b16 v[226:227], v16 offset:46080
    v_fma_f32 v136, v136, s28, v21
    v_fma_f32 v137, v137, s28, v21
    ds_read_b64_tr_b16 v[228:229], v17 offset:45056
    v_exp_f32 v136, v136
    v_exp_f32 v137, v137
    ds_read_b64_tr_b16 v[230:231], v17 offset:46080
    v_cvt_pk_bf16_f32 v163, v134, v135
    v_fma_f32 v138, v138, s28, v21
    ds_read_b64_tr_b16 v[232:233], v18 offset:45056
    v_fma_f32 v139, v139, s28, v21
    v_exp_f32 v138, v138
    ds_read_b64_tr_b16 v[234:235], v18 offset:46080
    v_exp_f32 v139, v139
    v_cvt_pk_bf16_f32 v164, v136, v137
    ds_read_b64_tr_b16 v[236:237], v19 offset:45056
    v_fma_f32 v140, v140, s28, v21
    v_fma_f32 v141, v141, s28, v21
    ds_read_b64_tr_b16 v[238:239], v19 offset:46080
    v_exp_f32 v140, v140
    v_exp_f32 v141, v141
    v_cvt_pk_bf16_f32 v165, v138, v139
    v_fma_f32 v142, v142, s28, v21
    v_fma_f32 v143, v143, s28, v21
    v_exp_f32 v142, v142
    v_exp_f32 v143, v143
    v_cvt_pk_bf16_f32 v166, v140, v141
    s_nop 0
    v_cvt_pk_bf16_f32 v167, v142, v143
    s_waitcnt lgkmcnt(15)
    s_nop 0
    v_mfma_f32_32x32x16_bf16 v[64:79], v[176:179], v[160:163], v[64:79]
    v_fma_f32 v144, v144, s28, v21
    v_fma_f32 v145, v145, s28, v21
    v_exp_f32 v144, v144
    v_exp_f32 v145, v145
    v_fma_f32 v146, v146, s28, v21
    v_fma_f32 v147, v147, s28, v21
    v_mfma_f32_32x32x16_bf16 v[80:95], v[180:183], v[160:163], v[80:95]
    v_exp_f32 v146, v146
    v_exp_f32 v147, v147
    v_cvt_pk_bf16_f32 v168, v144, v145
    v_fma_f32 v148, v148, s28, v21
    v_fma_f32 v149, v149, s28, v21
    v_mfma_f32_32x32x16_bf16 v[96:111], v[184:187], v[160:163], v[96:111]
    v_exp_f32 v148, v148
    v_exp_f32 v149, v149
    v_cvt_pk_bf16_f32 v169, v146, v147
    v_fma_f32 v150, v150, s28, v21
    v_fma_f32 v151, v151, s28, v21
    v_mfma_f32_32x32x16_bf16 v[112:127], v[188:191], v[160:163], v[112:127]
    v_exp_f32 v150, v150
    v_exp_f32 v151, v151
    v_cvt_pk_bf16_f32 v170, v148, v149
    v_fma_f32 v152, v152, s28, v21
    v_fma_f32 v153, v153, s28, v21
    v_mfma_f32_32x32x16_bf16 v[64:79], v[192:195], v[164:167], v[64:79]
    v_exp_f32 v152, v152
    v_exp_f32 v153, v153
    v_cvt_pk_bf16_f32 v171, v150, v151
    v_fma_f32 v154, v154, s28, v21
    v_fma_f32 v155, v155, s28, v21
    v_mfma_f32_32x32x16_bf16 v[80:95], v[196:199], v[164:167], v[80:95]
    v_exp_f32 v154, v154
    v_exp_f32 v155, v155
    v_cvt_pk_bf16_f32 v172, v152, v153
    v_fma_f32 v156, v156, s28, v21
    v_fma_f32 v157, v157, s28, v21
    v_mfma_f32_32x32x16_bf16 v[96:111], v[200:203], v[164:167], v[96:111]
    v_exp_f32 v156, v156
    v_exp_f32 v157, v157
    v_cvt_pk_bf16_f32 v173, v154, v155
    v_fma_f32 v158, v158, s28, v21
    v_fma_f32 v159, v159, s28, v21
    v_mfma_f32_32x32x16_bf16 v[112:127], v[204:207], v[164:167], v[112:127]
    v_exp_f32 v158, v158
    v_exp_f32 v159, v159
    v_cvt_pk_bf16_f32 v174, v156, v157
    s_nop 0
    v_cvt_pk_bf16_f32 v175, v158, v159
    s_waitcnt lgkmcnt(0)
    s_nop 0
    v_mfma_f32_32x32x16_bf16 v[64:79], v[208:211], v[168:171], v[64:79]
    v_add_f32 v26, v26, v128
    v_add_f32 v22, v22, v129
    v_add_f32 v26, v26, v130
    v_add_f32 v22, v22, v131
    v_mfma_f32_32x32x16_bf16 v[80:95], v[212:215], v[168:171], v[80:95]
    v_add_f32 v26, v26, v132
    v_add_f32 v22, v22, v133
    v_add_f32 v26, v26, v134
    v_add_f32 v22, v22, v135
    v_mfma_f32_32x32x16_bf16 v[96:111], v[216:219], v[168:171], v[96:111]
    v_add_f32 v26, v26, v136
    v_add_f32 v22, v22, v137
    v_add_f32 v26, v26, v138
    v_add_f32 v22, v22, v139
    v_mfma_f32_32x32x16_bf16 v[112:127], v[220:223], v[168:171], v[112:127]
    v_add_f32 v26, v26, v140
    v_add_f32 v22, v22, v141
    v_add_f32 v26, v26, v142
    v_add_f32 v22, v22, v143
    v_mfma_f32_32x32x16_bf16 v[64:79], v[224:227], v[172:175], v[64:79]
    v_add_f32 v26, v26, v144
    v_add_f32 v22, v22, v145
    v_add_f32 v26, v26, v146
    v_add_f32 v22, v22, v147
    v_mfma_f32_32x32x16_bf16 v[80:95], v[228:231], v[172:175], v[80:95]
    v_add_f32 v26, v26, v148
    v_add_f32 v22, v22, v149
    v_add_f32 v26, v26, v150
    v_add_f32 v22, v22, v151
    v_mfma_f32_32x32x16_bf16 v[96:111], v[232:235], v[172:175], v[96:111]
    v_add_f32 v26, v26, v152
    v_add_f32 v22, v22, v153
    v_add_f32 v26, v26, v154
    v_add_f32 v22, v22, v155
    v_mfma_f32_32x32x16_bf16 v[112:127], v[236:239], v[172:175], v[112:127]
    v_add_f32 v26, v26, v156
    v_add_f32 v22, v22, v157
    v_add_f32 v26, v26, v158
    v_add_f32 v22, v22, v159
    s_waitcnt vmcnt(4)
    s_barrier
    ds_read_b128 v[176:179], v8 offset:49152
    ds_read_b128 v[180:183], v9 offset:49152
    ds_read_b128 v[184:187], v10 offset:49152
    ds_read_b128 v[188:191], v11 offset:49152
    ds_read_b128 v[192:195], v12 offset:49152
    ds_read_b128 v[196:199], v13 offset:49152
    ds_read_b128 v[200:203], v14 offset:49152
    ds_read_b128 v[204:207], v15 offset:49152
    ds_read_b128 v[208:211], v8 offset:57344
    ds_read_b128 v[212:215], v9 offset:57344
    ds_read_b128 v[216:219], v10 offset:57344
    ds_read_b128 v[220:223], v11 offset:57344
    ds_read_b128 v[224:227], v12 offset:57344
    s_waitcnt lgkmcnt(12)
    v_mfma_f32_32x32x16_bf16 v[128:143], v[176:179], v[32:35], 0
    ds_read_b128 v[228:231], v13 offset:57344
    s_waitcnt lgkmcnt(12)
    v_mfma_f32_32x32x16_bf16 v[128:143], v[180:183], v[36:39], v[128:143]
    ds_read_b128 v[232:235], v14 offset:57344
    s_waitcnt lgkmcnt(12)
    v_mfma_f32_32x32x16_bf16 v[128:143], v[184:187], v[40:43], v[128:143]
    ds_read_b128 v[236:239], v15 offset:57344
    s_waitcnt lgkmcnt(12)
    v_mfma_f32_32x32x16_bf16 v[128:143], v[188:191], v[44:47], v[128:143]
    s_waitcnt lgkmcnt(11)
    v_mfma_f32_32x32x16_bf16 v[128:143], v[192:195], v[48:51], v[128:143]
    s_waitcnt lgkmcnt(10)
    v_mfma_f32_32x32x16_bf16 v[128:143], v[196:199], v[52:55], v[128:143]
    s_waitcnt lgkmcnt(9)
    v_mfma_f32_32x32x16_bf16 v[128:143], v[200:203], v[56:59], v[128:143]
    s_waitcnt lgkmcnt(8)
    v_mfma_f32_32x32x16_bf16 v[128:143], v[204:207], v[60:63], v[128:143]
    s_waitcnt lgkmcnt(7)
    v_mfma_f32_32x32x16_bf16 v[144:159], v[208:211], v[32:35], 0
    s_waitcnt lgkmcnt(6)
    v_mfma_f32_32x32x16_bf16 v[144:159], v[212:215], v[36:39], v[144:159]
    s_waitcnt lgkmcnt(5)
    v_mfma_f32_32x32x16_bf16 v[144:159], v[216:219], v[40:43], v[144:159]
    s_waitcnt lgkmcnt(4)
    v_mfma_f32_32x32x16_bf16 v[144:159], v[220:223], v[44:47], v[144:159]
    v_max3_f32 v23, v128, v129, v130
    v_max_f32 v23, v23, v131
    s_waitcnt lgkmcnt(3)
    v_mfma_f32_32x32x16_bf16 v[144:159], v[224:227], v[48:51], v[144:159]
    v_max3_f32 v23, v23, v132, v133
    v_max3_f32 v23, v23, v134, v135
    s_waitcnt lgkmcnt(2)
    v_mfma_f32_32x32x16_bf16 v[144:159], v[228:231], v[52:55], v[144:159]
    v_max3_f32 v23, v23, v136, v137
    s_waitcnt lgkmcnt(1)
    v_mfma_f32_32x32x16_bf16 v[144:159], v[232:235], v[56:59], v[144:159]
    v_max3_f32 v23, v23, v138, v139
    v_max3_f32 v23, v23, v140, v141
    s_waitcnt lgkmcnt(0)
    v_mfma_f32_32x32x16_bf16 v[144:159], v[236:239], v[60:63], v[144:159]
    v_max3_f32 v23, v23, v142, v143
    s_waitcnt vmcnt(0)
    s_barrier
    ds_read_b64_tr_b16 v[176:177], v16 offset:0
    ds_read_b64_tr_b16 v[178:179], v16 offset:1024
    ds_read_b64_tr_b16 v[180:181], v17 offset:0
    ds_read_b64_tr_b16 v[182:183], v17 offset:1024
    ds_read_b64_tr_b16 v[184:185], v18 offset:0
    ds_read_b64_tr_b16 v[186:187], v18 offset:1024
    ds_read_b64_tr_b16 v[188:189], v19 offset:0
    ds_read_b64_tr_b16 v[190:191], v19 offset:1024
    ds_read_b64_tr_b16 v[192:193], v16 offset:4096
    ds_read_b64_tr_b16 v[194:195], v16 offset:5120
    ds_read_b64_tr_b16 v[196:197], v17 offset:4096
    ds_read_b64_tr_b16 v[198:199], v17 offset:5120
    v_max3_f32 v23, v23, v144, v145
    v_max3_f32 v23, v23, v146, v147
    v_max3_f32 v23, v23, v148, v149
    v_max3_f32 v23, v23, v150, v151
    v_max3_f32 v23, v23, v152, v153
    v_max3_f32 v23, v23, v154, v155
    v_max3_f32 v23, v23, v156, v157
    v_max3_f32 v23, v23, v158, v159
    v_mov_b32 v24, v23
    ds_read_b64_tr_b16 v[200:201], v18 offset:4096
    ds_read_b64_tr_b16 v[202:203], v18 offset:5120
    v_permlane32_swap_b32 v23, v24
    ds_read_b64_tr_b16 v[204:205], v19 offset:4096
    ds_read_b64_tr_b16 v[206:207], v19 offset:5120
    v_max_f32 v23, v23, v24
    v_sub_f32 v24, v23, v20
    v_cmp_lt_f32 vcc, s29, v24
    s_cbranch_vccz K1_SKIP4
    v_max_f32 v23, v23, v20
    v_sub_f32 v24, v20, v23
    v_mul_f32 v24, s28, v24
    v_exp_f32 v24, v24
    v_mov_b32 v20, v23
    v_mul_f32 v21, s28, v23
    v_sub_f32 v21, 0, v21
    v_mul_f32 v22, v22, v24
    v_mul_f32 v26, v26, v24
    v_mul_f32 v64, v64, v24
    v_mul_f32 v65, v65, v24
    v_mul_f32 v66, v66, v24
    v_mul_f32 v67, v67, v24
    v_mul_f32 v68, v68, v24
    v_mul_f32 v69, v69, v24
    v_mul_f32 v70, v70, v24
    v_mul_f32 v71, v71, v24
    v_mul_f32 v72, v72, v24
    v_mul_f32 v73, v73, v24
    v_mul_f32 v74, v74, v24
    v_mul_f32 v75, v75, v24
    v_mul_f32 v76, v76, v24
    v_mul_f32 v77, v77, v24
    v_mul_f32 v78, v78, v24
    v_mul_f32 v79, v79, v24
    v_mul_f32 v80, v80, v24
    v_mul_f32 v81, v81, v24
    v_mul_f32 v82, v82, v24
    v_mul_f32 v83, v83, v24
    v_mul_f32 v84, v84, v24
    v_mul_f32 v85, v85, v24
    v_mul_f32 v86, v86, v24
    v_mul_f32 v87, v87, v24
    v_mul_f32 v88, v88, v24
    v_mul_f32 v89, v89, v24
    v_mul_f32 v90, v90, v24
    v_mul_f32 v91, v91, v24
    v_mul_f32 v92, v92, v24
    v_mul_f32 v93, v93, v24
    v_mul_f32 v94, v94, v24
    v_mul_f32 v95, v95, v24
    v_mul_f32 v96, v96, v24
    v_mul_f32 v97, v97, v24
    v_mul_f32 v98, v98, v24
    v_mul_f32 v99, v99, v24
    v_mul_f32 v100, v100, v24
    v_mul_f32 v101, v101, v24
    v_mul_f32 v102, v102, v24
    v_mul_f32 v103, v103, v24
    v_mul_f32 v104, v104, v24
    v_mul_f32 v105, v105, v24
    v_mul_f32 v106, v106, v24
    v_mul_f32 v107, v107, v24
    v_mul_f32 v108, v108, v24
    v_mul_f32 v109, v109, v24
    v_mul_f32 v110, v110, v24
    v_mul_f32 v111, v111, v24
    v_mul_f32 v112, v112, v24
    v_mul_f32 v113, v113, v24
    v_mul_f32 v114, v114, v24
    v_mul_f32 v115, v115, v24
    v_mul_f32 v116, v116, v24
    v_mul_f32 v117, v117, v24
    v_mul_f32 v118, v118, v24
    v_mul_f32 v119, v119, v24
    v_mul_f32 v120, v120, v24
    v_mul_f32 v121, v121, v24
    v_mul_f32 v122, v122, v24
    v_mul_f32 v123, v123, v24
    v_mul_f32 v124, v124, v24
    v_mul_f32 v125, v125, v24
    v_mul_f32 v126, v126, v24
    v_mul_f32 v127, v127, v24
K1_SKIP4:
    v_fma_f32 v128, v128, s28, v21
    ds_read_b64_tr_b16 v[208:209], v16 offset:8192
    v_fma_f32 v129, v129, s28, v21
    v_exp_f32 v128, v128
    ds_read_b64_tr_b16 v[210:211], v16 offset:9216
    v_exp_f32 v129, v129
    v_fma_f32 v130, v130, s28, v21
    ds_read_b64_tr_b16 v[212:213], v17 offset:8192
    v_fma_f32 v131, v131, s28, v21
    v_exp_f32 v130, v130
    ds_read_b64_tr_b16 v[214:215], v17 offset:9216
    v_exp_f32 v131, v131
    v_cvt_pk_bf16_f32 v160, v128, v129
    ds_read_b64_tr_b16 v[216:217], v18 offset:8192
    v_fma_f32 v132, v132, s28, v21
    v_fma_f32 v133, v133, s28, v21
    ds_read_b64_tr_b16 v[218:219], v18 offset:9216
    v_exp_f32 v132, v132
    v_exp_f32 v133, v133
    ds_read_b64_tr_b16 v[220:221], v19 offset:8192
    v_cvt_pk_bf16_f32 v161, v130, v131
    v_fma_f32 v134, v134, s28, v21
    ds_read_b64_tr_b16 v[222:223], v19 offset:9216
    v_fma_f32 v135, v135, s28, v21
    v_exp_f32 v134, v134
    ds_read_b64_tr_b16 v[224:225], v16 offset:12288
    v_exp_f32 v135, v135
    v_cvt_pk_bf16_f32 v162, v132, v133
    ds_read_b64_tr_b16 v[226:227], v16 offset:13312
    v_fma_f32 v136, v136, s28, v21
    v_fma_f32 v137, v137, s28, v21
    ds_read_b64_tr_b16 v[228:229], v17 offset:12288
    v_exp_f32 v136, v136
    v_exp_f32 v137, v137
    ds_read_b64_tr_b16 v[230:231], v17 offset:13312
    v_cvt_pk_bf16_f32 v163, v134, v135
    v_fma_f32 v138, v138, s28, v21
    ds_read_b64_tr_b16 v[232:233], v18 offset:12288
    v_fma_f32 v139, v139, s28, v21
    v_exp_f32 v138, v138
    ds_read_b64_tr_b16 v[234:235], v18 offset:13312
    v_exp_f32 v139, v139
    v_cvt_pk_bf16_f32 v164, v136, v137
    ds_read_b64_tr_b16 v[236:237], v19 offset:12288
    v_fma_f32 v140, v140, s28, v21
    v_fma_f32 v141, v141, s28, v21
    ds_read_b64_tr_b16 v[238:239], v19 offset:13312
    v_exp_f32 v140, v140
    v_exp_f32 v141, v141
    v_cvt_pk_bf16_f32 v165, v138, v139
    v_fma_f32 v142, v142, s28, v21
    v_fma_f32 v143, v143, s28, v21
    v_exp_f32 v142, v142
    v_exp_f32 v143, v143
    v_cvt_pk_bf16_f32 v166, v140, v141
    s_nop 0
    v_cvt_pk_bf16_f32 v167, v142, v143
    s_waitcnt lgkmcnt(15)
    s_nop 0
    v_mfma_f32_32x32x16_bf16 v[64:79], v[176:179], v[160:163], v[64:79]
    v_fma_f32 v144, v144, s28, v21
    v_fma_f32 v145, v145, s28, v21
    v_exp_f32 v144, v144
    v_exp_f32 v145, v145
    v_fma_f32 v146, v146, s28, v21
    v_fma_f32 v147, v147, s28, v21
    v_mfma_f32_32x32x16_bf16 v[80:95], v[180:183], v[160:163], v[80:95]
    v_exp_f32 v146, v146
    v_exp_f32 v147, v147
    v_cvt_pk_bf16_f32 v168, v144, v145
    v_fma_f32 v148, v148, s28, v21
    v_fma_f32 v149, v149, s28, v21
    v_mfma_f32_32x32x16_bf16 v[96:111], v[184:187], v[160:163], v[96:111]
    v_exp_f32 v148, v148
    v_exp_f32 v149, v149
    v_cvt_pk_bf16_f32 v169, v146, v147
    v_fma_f32 v150, v150, s28, v21
    v_fma_f32 v151, v151, s28, v21
    v_mfma_f32_32x32x16_bf16 v[112:127], v[188:191], v[160:163], v[112:127]
    v_exp_f32 v150, v150
    v_exp_f32 v151, v151
    v_cvt_pk_bf16_f32 v170, v148, v149
    v_fma_f32 v152, v152, s28, v21
    v_fma_f32 v153, v153, s28, v21
    v_mfma_f32_32x32x16_bf16 v[64:79], v[192:195], v[164:167], v[64:79]
    v_exp_f32 v152, v152
    v_exp_f32 v153, v153
    v_cvt_pk_bf16_f32 v171, v150, v151
    v_fma_f32 v154, v154, s28, v21
    v_fma_f32 v155, v155, s28, v21
    v_mfma_f32_32x32x16_bf16 v[80:95], v[196:199], v[164:167], v[80:95]
    v_exp_f32 v154, v154
    v_exp_f32 v155, v155
    v_cvt_pk_bf16_f32 v172, v152, v153
    v_fma_f32 v156, v156, s28, v21
    v_fma_f32 v157, v157, s28, v21
    v_mfma_f32_32x32x16_bf16 v[96:111], v[200:203], v[164:167], v[96:111]
    v_exp_f32 v156, v156
    v_exp_f32 v157, v157
    v_cvt_pk_bf16_f32 v173, v154, v155
    v_fma_f32 v158, v158, s28, v21
    v_fma_f32 v159, v159, s28, v21
    v_mfma_f32_32x32x16_bf16 v[112:127], v[204:207], v[164:167], v[112:127]
    v_exp_f32 v158, v158
    v_exp_f32 v159, v159
    v_cvt_pk_bf16_f32 v174, v156, v157
    s_nop 0
    v_cvt_pk_bf16_f32 v175, v158, v159
    s_waitcnt lgkmcnt(0)
    s_nop 0
    v_mfma_f32_32x32x16_bf16 v[64:79], v[208:211], v[168:171], v[64:79]
    v_add_f32 v26, v26, v128
    v_add_f32 v22, v22, v129
    v_add_f32 v26, v26, v130
    v_add_f32 v22, v22, v131
    v_mfma_f32_32x32x16_bf16 v[80:95], v[212:215], v[168:171], v[80:95]
    v_add_f32 v26, v26, v132
    v_add_f32 v22, v22, v133
    v_add_f32 v26, v26, v134
    v_add_f32 v22, v22, v135
    v_mfma_f32_32x32x16_bf16 v[96:111], v[216:219], v[168:171], v[96:111]
    v_add_f32 v26, v26, v136
    v_add_f32 v22, v22, v137
    v_add_f32 v26, v26, v138
    v_add_f32 v22, v22, v139
    v_mfma_f32_32x32x16_bf16 v[112:127], v[220:223], v[168:171], v[112:127]
    v_add_f32 v26, v26, v140
    v_add_f32 v22, v22, v141
    v_add_f32 v26, v26, v142
    v_add_f32 v22, v22, v143
    v_mfma_f32_32x32x16_bf16 v[64:79], v[224:227], v[172:175], v[64:79]
    v_add_f32 v26, v26, v144
    v_add_f32 v22, v22, v145
    v_add_f32 v26, v26, v146
    v_add_f32 v22, v22, v147
    v_mfma_f32_32x32x16_bf16 v[80:95], v[228:231], v[172:175], v[80:95]
    v_add_f32 v26, v26, v148
    v_add_f32 v22, v22, v149
    v_add_f32 v26, v26, v150
    v_add_f32 v22, v22, v151
    v_mfma_f32_32x32x16_bf16 v[96:111], v[232:235], v[172:175], v[96:111]
    v_add_f32 v26, v26, v152
    v_add_f32 v22, v22, v153
    v_add_f32 v26, v26, v154
    v_add_f32 v22, v22, v155
    v_mfma_f32_32x32x16_bf16 v[112:127], v[236:239], v[172:175], v[112:127]
    v_add_f32 v26, v26, v156
    v_add_f32 v22, v22, v157
    v_add_f32 v26, v26, v158
    v_add_f32 v22, v22, v159
    s_load_dwordx2 s[48:49], s[0:1], 32
    s_and_b32 s34, s2, 511
    s_lshl_b32 s34, s34, 2
    s_add_u32 s34, s34, s7
    s_mul_i32 s34, s34, 2304
    v_lshlrev_b32 v240, 7, v0
    s_mov_b32 s50, 2304
    s_mov_b32 s51, 0x20000
    s_waitcnt lgkmcnt(0)
    s_add_u32 s48, s48, s34
    s_addc_u32 s49, s49, 0
    buffer_load_dword v241, v240, s[48:51], 0 offen
    v_add_f32 v22, v22, v26
    v_mov_b32 v24, v22
    s_nop 1
    v_permlane32_swap_b32 v22, v24
    s_nop 1
    v_add_f32 v22, v22, v24
    v_rcp_f32 v22, v22
    s_nop 7
    v_mul_f32 v64, v64, v22
    v_mul_f32 v65, v65, v22
    v_mul_f32 v66, v66, v22
    v_mul_f32 v67, v67, v22
    v_mul_f32 v68, v68, v22
    v_mul_f32 v69, v69, v22
    v_mul_f32 v70, v70, v22
    v_mul_f32 v71, v71, v22
    v_cvt_pk_bf16_f32 v128, v64, v65
    v_cvt_pk_bf16_f32 v129, v66, v67
    v_cvt_pk_bf16_f32 v130, v68, v69
    v_cvt_pk_bf16_f32 v131, v70, v71
    s_mov_b32 s34, 0
    buffer_store_dwordx4 v[128:131], v27, s[24:27], s34 offen sc0 sc1
    v_mul_f32 v72, v72, v22
    v_mul_f32 v73, v73, v22
    v_mul_f32 v74, v74, v22
    v_mul_f32 v75, v75, v22
    v_mul_f32 v76, v76, v22
    v_mul_f32 v77, v77, v22
    v_mul_f32 v78, v78, v22
    v_mul_f32 v79, v79, v22
    v_cvt_pk_bf16_f32 v132, v72, v73
    v_cvt_pk_bf16_f32 v133, v74, v75
    v_cvt_pk_bf16_f32 v134, v76, v77
    v_cvt_pk_bf16_f32 v135, v78, v79
    s_mov_b32 s34, 57344
    buffer_store_dwordx4 v[132:135], v27, s[24:27], s34 offen sc0 sc1
    v_mul_f32 v80, v80, v22
    v_mul_f32 v81, v81, v22
    v_mul_f32 v82, v82, v22
    v_mul_f32 v83, v83, v22
    v_mul_f32 v84, v84, v22
    v_mul_f32 v85, v85, v22
    v_mul_f32 v86, v86, v22
    v_mul_f32 v87, v87, v22
    v_cvt_pk_bf16_f32 v136, v80, v81
    v_cvt_pk_bf16_f32 v137, v82, v83
    v_cvt_pk_bf16_f32 v138, v84, v85
    v_cvt_pk_bf16_f32 v139, v86, v87
    s_mov_b32 s34, 114688
    buffer_store_dwordx4 v[136:139], v27, s[24:27], s34 offen sc0 sc1
    v_mul_f32 v88, v88, v22
    v_mul_f32 v89, v89, v22
    v_mul_f32 v90, v90, v22
    v_mul_f32 v91, v91, v22
    v_mul_f32 v92, v92, v22
    v_mul_f32 v93, v93, v22
    v_mul_f32 v94, v94, v22
    v_mul_f32 v95, v95, v22
    v_cvt_pk_bf16_f32 v140, v88, v89
    v_cvt_pk_bf16_f32 v141, v90, v91
    v_cvt_pk_bf16_f32 v142, v92, v93
    v_cvt_pk_bf16_f32 v143, v94, v95
    s_mov_b32 s34, 172032
    buffer_store_dwordx4 v[140:143], v27, s[24:27], s34 offen sc0 sc1
    v_mul_f32 v96, v96, v22
    v_mul_f32 v97, v97, v22
    v_mul_f32 v98, v98, v22
    v_mul_f32 v99, v99, v22
    v_mul_f32 v100, v100, v22
    v_mul_f32 v101, v101, v22
    v_mul_f32 v102, v102, v22
    v_mul_f32 v103, v103, v22
    v_cvt_pk_bf16_f32 v144, v96, v97
    v_cvt_pk_bf16_f32 v145, v98, v99
    v_cvt_pk_bf16_f32 v146, v100, v101
    v_cvt_pk_bf16_f32 v147, v102, v103
    s_mov_b32 s34, 229376
    buffer_store_dwordx4 v[144:147], v27, s[24:27], s34 offen sc0 sc1
    v_mul_f32 v104, v104, v22
    v_mul_f32 v105, v105, v22
    v_mul_f32 v106, v106, v22
    v_mul_f32 v107, v107, v22
    v_mul_f32 v108, v108, v22
    v_mul_f32 v109, v109, v22
    v_mul_f32 v110, v110, v22
    v_mul_f32 v111, v111, v22
    v_cvt_pk_bf16_f32 v148, v104, v105
    v_cvt_pk_bf16_f32 v149, v106, v107
    v_cvt_pk_bf16_f32 v150, v108, v109
    v_cvt_pk_bf16_f32 v151, v110, v111
    s_mov_b32 s34, 286720
    buffer_store_dwordx4 v[148:151], v27, s[24:27], s34 offen sc0 sc1
    v_mul_f32 v112, v112, v22
    v_mul_f32 v113, v113, v22
    v_mul_f32 v114, v114, v22
    v_mul_f32 v115, v115, v22
    v_mul_f32 v116, v116, v22
    v_mul_f32 v117, v117, v22
    v_mul_f32 v118, v118, v22
    v_mul_f32 v119, v119, v22
    v_cvt_pk_bf16_f32 v152, v112, v113
    v_cvt_pk_bf16_f32 v153, v114, v115
    v_cvt_pk_bf16_f32 v154, v116, v117
    v_cvt_pk_bf16_f32 v155, v118, v119
    s_mov_b32 s34, 344064
    buffer_store_dwordx4 v[152:155], v27, s[24:27], s34 offen sc0 sc1
    v_mul_f32 v120, v120, v22
    v_mul_f32 v121, v121, v22
    v_mul_f32 v122, v122, v22
    v_mul_f32 v123, v123, v22
    v_mul_f32 v124, v124, v22
    v_mul_f32 v125, v125, v22
    v_mul_f32 v126, v126, v22
    v_mul_f32 v127, v127, v22
    v_cvt_pk_bf16_f32 v156, v120, v121
    v_cvt_pk_bf16_f32 v157, v122, v123
    v_cvt_pk_bf16_f32 v158, v124, v125
    v_cvt_pk_bf16_f32 v159, v126, v127
    s_mov_b32 s34, 401408
    buffer_store_dwordx4 v[156:159], v27, s[24:27], s34 offen sc0 sc1
K1_END:
    s_endpgm
.text
.globl oproj_kernel
.p2align 8
.type oproj_kernel,@function
oproj_kernel:
    s_cmp_ge_u32 s2, 256
    s_cbranch_scc1 K2_END
    s_and_b32 s3, s2, 1
    s_lshr_b32 s4, s2, 3
    s_lshl_b32 s3, s3, 5
    s_add_u32 s3, s3, s4
    s_cmp_ge_u32 s3, 63
    s_cbranch_scc1 K2_END
    s_load_dwordx4 s[36:39], s[0:1], 32
    s_load_dwordx2 s[44:45], s[0:1], 56
    s_mul_i32 s5, s3, 9363
    s_lshr_b32 s5, s5, 16
    s_mul_i32 s4, s5, 7
    s_sub_u32 s4, s3, s4
    s_bfe_u32 s3, s2, 0x20001
    s_mul_i32 s3, s3, 7
    s_add_u32 s4, s4, s3
    s_mul_i32 s3, s4, 9
    s_add_u32 s3, s3, s5
    v_lshrrev_b32 v8, 6, v0
    v_and_b32 v0, 63, v0
    v_readfirstlane_b32 s7, v8
    v_lshrrev_b32 v9, 3, v0
    v_bfe_u32 v10, v0, 4, 1
    v_lshlrev_b32 v10, 2, v10
    v_and_b32 v11, 7, v0
    v_xor_b32 v10, v10, v11
    v_mul_u32_u24 v1, 1152, v9
    v_lshl_add_u32 v1, v10, 4, v1
    v_and_b32 v9, 31, v0
    v_lshrrev_b32 v10, 5, v0
    v_mul_u32_u24 v2, 28672, v10
    v_lshl_add_u32 v2, v9, 4, v2
    s_lshl_b32 s30, s7, 14
    s_waitcnt lgkmcnt(0)
    s_mul_i32 s34, s7, 589824
    s_lshl_b32 s35, s5, 7
    s_add_u32 s34, s34, s35
    s_add_u32 s36, s36, s34
    s_addc_u32 s37, s37, 0
    s_mul_i32 s34, s7, 1835008
    s_lshl_b32 s33, s4, 10
    s_add_u32 s34, s34, s33
    s_add_u32 s44, s44, s34
    s_addc_u32 s45, s45, 0
    s_mul_i32 s34, s4, 73728
    s_add_u32 s34, s34, s35
    s_add_u32 s38, s38, s34
    s_addc_u32 s39, s39, 0
    s_mov_b32 s8, s36
    s_mov_b32 s9, s37
    s_mov_b32 s10, 588800
    s_mov_b32 s11, 0x00020000
    s_mov_b32 s12, s44
    s_mov_b32 s13, s45
    s_mov_b32 s14, 1807360
    s_mov_b32 s15, 0x00020000
    s_mov_b32 s16, s38
    s_mov_b32 s17, s39
    s_mov_b32 s18, 72704
    s_mov_b32 s19, 0x00020000
    s_mul_i32 s46, s5, 2
    s_mul_i32 s47, s4, 4
    s_add_u32 s46, s46, s47
    s_add_u32 m0, s30, 0
    s_and_b32 s47, s46, 0
    s_add_u32 s47, s47, 0
    s_add_u32 s46, s46, 1
    s_mul_i32 s34, s47, 36864
    s_mul_i32 s35, s47, 114688
    buffer_load_dwordx4 v1, s[8:11], s34 offen offset:0 lds
    s_add_u32 s34, s34, 8192
    buffer_load_dwordx4 v1, s[8:11], s34 offen offset:1024 lds
    s_add_u32 s34, s34, 8192
    buffer_load_dwordx4 v1, s[8:11], s34 offen offset:2048 lds
    s_add_u32 s34, s34, 8192
    buffer_load_dwordx4 v1, s[8:11], s34 offen offset:3072 lds
    s_add_u32 s34, s34, 8192
    buffer_load_dwordx4 v[112:115], v2, s[12:15], s35 offen offset:0
    buffer_load_dwordx4 v[116:119], v2, s[12:15], s35 offen offset:512
    s_add_u32 s35, s35, 57344
    buffer_load_dwordx4 v[120:123], v2, s[12:15], s35 offen offset:0
    buffer_load_dwordx4 v[124:127], v2, s[12:15], s35 offen offset:512
    s_add_u32 s35, s35, 57344
    s_add_u32 m0, s30, 4096
    s_and_b32 s47, s46, 0
    s_add_u32 s47, s47, 1
    s_add_u32 s46, s46, 1
    s_mul_i32 s34, s47, 36864
    s_mul_i32 s35, s47, 114688
    buffer_load_dwordx4 v1, s[8:11], s34 offen offset:0 lds
    s_add_u32 s34, s34, 8192
    buffer_load_dwordx4 v1, s[8:11], s34 offen offset:1024 lds
    s_add_u32 s34, s34, 8192
    buffer_load_dwordx4 v1, s[8:11], s34 offen offset:2048 lds
    s_add_u32 s34, s34, 8192
    buffer_load_dwordx4 v1, s[8:11], s34 offen offset:3072 lds
    s_add_u32 s34, s34, 8192
    buffer_load_dwordx4 v[128:131], v2, s[12:15], s35 offen offset:0
    buffer_load_dwordx4 v[132:135], v2, s[12:15], s35 offen offset:512
    s_add_u32 s35, s35, 57344
    buffer_load_dwordx4 v[136:139], v2, s[12:15], s35 offen offset:0
    buffer_load_dwordx4 v[140:143], v2, s[12:15], s35 offen offset:512
    s_add_u32 s35, s35, 57344
    s_add_u32 m0, s30, 8192
    s_and_b32 s47, s46, 0
    s_add_u32 s47, s47, 2
    s_add_u32 s46, s46, 1
    s_mul_i32 s34, s47, 36864
    s_mul_i32 s35, s47, 114688
    buffer_load_dwordx4 v1, s[8:11], s34 offen offset:0 lds
    s_add_u32 s34, s34, 8192
    buffer_load_dwordx4 v1, s[8:11], s34 offen offset:1024 lds
    s_add_u32 s34, s34, 8192
    buffer_load_dwordx4 v1, s[8:11], s34 offen offset:2048 lds
    s_add_u32 s34, s34, 8192
    buffer_load_dwordx4 v1, s[8:11], s34 offen offset:3072 lds
    s_add_u32 s34, s34, 8192
    buffer_load_dwordx4 v[144:147], v2, s[12:15], s35 offen offset:0
    buffer_load_dwordx4 v[148:151], v2, s[12:15], s35 offen offset:512
    s_add_u32 s35, s35, 57344
    buffer_load_dwordx4 v[152:155], v2, s[12:15], s35 offen offset:0
    buffer_load_dwordx4 v[156:159], v2, s[12:15], s35 offen offset:512
    s_add_u32 s35, s35, 57344
    v_bfe_u32 v11, v0, 2, 2
    v_and_b32 v12, 1, v0
    v_bfe_u32 v13, v0, 1, 1
    v_lshl_or_b32 v12, v12, 1, v13
    v_lshlrev_b32 v12, 3, v12
    v_bfe_u32 v13, v0, 4, 1
    v_lshl_or_b32 v12, v13, 5, v12
    v_lshl_add_u32 v13, v10, 3, v11
    v_lshl_add_u32 v12, v13, 7, v12
    v_add_u32 v12, s30, v12
    v_lshrrev_b32 v11, 1, v11
    v_lshl_add_u32 v3, v11, 6, v12
    v_xor_b32 v11, 1, v11
    v_lshl_add_u32 v4, v11, 6, v12
    v_lshlrev_b32 v5, 4, v0
    s_lshr_b32 s34, s7, 1
    s_and_b32 s34, s34, 1
    s_mul_i32 s34, s34, 36864
    s_lshr_b32 s35, s7, 2
    s_lshl_b32 s35, s35, 6
    s_add_u32 s34, s34, s35
    s_and_b32 s35, s7, 1
    s_lshl_b32 s35, s35, 5
    s_add_u32 s34, s34, s35
    v_mul_u32_u24 v6, 1152, v9
    v_lshl_add_u32 v6, v10, 4, v6
    v_add_u32 v6, s34, v6
    s_setprio 3
    s_waitcnt vmcnt(16)
    ds_read_b64_tr_b16 v[80:81], v3 offset:0
    ds_read_b64_tr_b16 v[82:83], v3 offset:512
    ds_read_b64_tr_b16 v[84:85], v4 offset:0
    ds_read_b64_tr_b16 v[86:87], v4 offset:512
    ds_read_b64_tr_b16 v[88:89], v3 offset:2048
    ds_read_b64_tr_b16 v[90:91], v3 offset:2560
    ds_read_b64_tr_b16 v[92:93], v4 offset:2048
    ds_read_b64_tr_b16 v[94:95], v4 offset:2560
    s_add_u32 m0, s30, 12288
    s_and_b32 s47, s46, 0
    s_add_u32 s47, s47, 3
    s_add_u32 s46, s46, 1
    s_mul_i32 s34, s47, 36864
    s_mul_i32 s35, s47, 114688
    buffer_load_dwordx4 v1, s[8:11], s34 offen offset:0 lds
    s_waitcnt lgkmcnt(4)
    v_mfma_f32_32x32x16_bf16 v[16:31], v[80:83], v[112:115], 0
    s_add_u32 s34, s34, 8192
    buffer_load_dwordx4 v1, s[8:11], s34 offen offset:1024 lds
    v_mfma_f32_32x32x16_bf16 v[32:47], v[80:83], v[116:119], 0
    s_add_u32 s34, s34, 8192
    buffer_load_dwordx4 v1, s[8:11], s34 offen offset:2048 lds
    v_mfma_f32_32x32x16_bf16 v[48:63], v[84:87], v[112:115], 0
    s_add_u32 s34, s34, 8192
    buffer_load_dwordx4 v1, s[8:11], s34 offen offset:3072 lds
    v_mfma_f32_32x32x16_bf16 v[64:79], v[84:87], v[116:119], 0
    s_add_u32 s34, s34, 8192
    buffer_load_dwordx4 v[160:163], v2, s[12:15], s35 offen offset:0
    s_waitcnt lgkmcnt(0)
    v_mfma_f32_32x32x16_bf16 v[16:31], v[88:91], v[120:123], v[16:31]
    buffer_load_dwordx4 v[164:167], v2, s[12:15], s35 offen offset:512
    s_add_u32 s35, s35, 57344
    v_mfma_f32_32x32x16_bf16 v[32:47], v[88:91], v[124:127], v[32:47]
    buffer_load_dwordx4 v[168:171], v2, s[12:15], s35 offen offset:0
    buffer_load_dwordx4 v[172:175], v2, s[12:15], s35 offen offset:512
    v_mfma_f32_32x32x16_bf16 v[48:63], v[92:95], v[120:123], v[48:63]
    s_add_u32 s35, s35, 57344
    v_mfma_f32_32x32x16_bf16 v[64:79], v[92:95], v[124:127], v[64:79]
    s_waitcnt vmcnt(16)
    ds_read_b64_tr_b16 v[96:97], v3 offset:4096
    ds_read_b64_tr_b16 v[98:99], v3 offset:4608
    ds_read_b64_tr_b16 v[100:101], v4 offset:4096
    ds_read_b64_tr_b16 v[102:103], v4 offset:4608
    ds_read_b64_tr_b16 v[104:105], v3 offset:6144
    ds_read_b64_tr_b16 v[106:107], v3 offset:6656
    ds_read_b64_tr_b16 v[108:109], v4 offset:6144
    ds_read_b64_tr_b16 v[110:111], v4 offset:6656
    s_add_u32 m0, s30, 0
    s_and_b32 s47, s46, 0
    s_add_u32 s47, s47, 4
    s_add_u32 s46, s46, 1
    s_mul_i32 s34, s47, 36864
    s_mul_i32 s35, s47, 114688
    buffer_load_dwordx4 v1, s[8:11], s34 offen offset:0 lds
    s_waitcnt lgkmcnt(4)
    v_mfma_f32_32x32x16_bf16 v[16:31], v[96:99], v[128:131], v[16:31]
    s_add_u32 s34, s34, 8192
    buffer_load_dwordx4 v1, s[8:11], s34 offen offset:1024 lds
    v_mfma_f32_32x32x16_bf16 v[32:47], v[96:99], v[132:135], v[32:47]
    s_add_u32 s34, s34, 8192
    buffer_load_dwordx4 v1, s[8:11], s34 offen offset:2048 lds
    v_mfma_f32_32x32x16_bf16 v[48:63], v[100:103], v[128:131], v[48:63]
    s_add_u32 s34, s34, 8192
    buffer_load_dwordx4 v1, s[8:11], s34 offen offset:3072 lds
    v_mfma_f32_32x32x16_bf16 v[64:79], v[100:103], v[132:135], v[64:79]
    s_add_u32 s34, s34, 8192
    buffer_load_dwordx4 v[112:115], v2, s[12:15], s35 offen offset:0
    s_waitcnt lgkmcnt(0)
    v_mfma_f32_32x32x16_bf16 v[16:31], v[104:107], v[136:139], v[16:31]
    buffer_load_dwordx4 v[116:119], v2, s[12:15], s35 offen offset:512
    s_add_u32 s35, s35, 57344
    v_mfma_f32_32x32x16_bf16 v[32:47], v[104:107], v[140:143], v[32:47]
    buffer_load_dwordx4 v[120:123], v2, s[12:15], s35 offen offset:0
    buffer_load_dwordx4 v[124:127], v2, s[12:15], s35 offen offset:512
    v_mfma_f32_32x32x16_bf16 v[48:63], v[108:111], v[136:139], v[48:63]
    s_add_u32 s35, s35, 57344
    v_mfma_f32_32x32x16_bf16 v[64:79], v[108:111], v[140:143], v[64:79]
    s_waitcnt vmcnt(16)
    ds_read_b64_tr_b16 v[80:81], v3 offset:8192
    ds_read_b64_tr_b16 v[82:83], v3 offset:8704
    ds_read_b64_tr_b16 v[84:85], v4 offset:8192
    ds_read_b64_tr_b16 v[86:87], v4 offset:8704
    ds_read_b64_tr_b16 v[88:89], v3 offset:10240
    ds_read_b64_tr_b16 v[90:91], v3 offset:10752
    ds_read_b64_tr_b16 v[92:93], v4 offset:10240
    ds_read_b64_tr_b16 v[94:95], v4 offset:10752
    s_add_u32 m0, s30, 4096
    s_and_b32 s47, s46, 0
    s_add_u32 s47, s47, 5
    s_add_u32 s46, s46, 1
    s_mul_i32 s34, s47, 36864
    s_mul_i32 s35, s47, 114688
    buffer_load_dwordx4 v1, s[8:11], s34 offen offset:0 lds
    s_waitcnt lgkmcnt(4)
    v_mfma_f32_32x32x16_bf16 v[16:31], v[80:83], v[144:147], v[16:31]
    s_add_u32 s34, s34, 8192
    buffer_load_dwordx4 v1, s[8:11], s34 offen offset:1024 lds
    v_mfma_f32_32x32x16_bf16 v[32:47], v[80:83], v[148:151], v[32:47]
    s_add_u32 s34, s34, 8192
    buffer_load_dwordx4 v1, s[8:11], s34 offen offset:2048 lds
    v_mfma_f32_32x32x16_bf16 v[48:63], v[84:87], v[144:147], v[48:63]
    s_add_u32 s34, s34, 8192
    buffer_load_dwordx4 v1, s[8:11], s34 offen offset:3072 lds
    v_mfma_f32_32x32x16_bf16 v[64:79], v[84:87], v[148:151], v[64:79]
    s_add_u32 s34, s34, 8192
    buffer_load_dwordx4 v[128:131], v2, s[12:15], s35 offen offset:0
    s_waitcnt lgkmcnt(0)
    v_mfma_f32_32x32x16_bf16 v[16:31], v[88:91], v[152:155], v[16:31]
    buffer_load_dwordx4 v[132:135], v2, s[12:15], s35 offen offset:512
    s_add_u32 s35, s35, 57344
    v_mfma_f32_32x32x16_bf16 v[32:47], v[88:91], v[156:159], v[32:47]
    buffer_load_dwordx4 v[136:139], v2, s[12:15], s35 offen offset:0
    buffer_load_dwordx4 v[140:143], v2, s[12:15], s35 offen offset:512
    v_mfma_f32_32x32x16_bf16 v[48:63], v[92:95], v[152:155], v[48:63]
    s_add_u32 s35, s35, 57344
    v_mfma_f32_32x32x16_bf16 v[64:79], v[92:95], v[156:159], v[64:79]
    s_waitcnt vmcnt(16)
    ds_read_b64_tr_b16 v[96:97], v3 offset:12288
    ds_read_b64_tr_b16 v[98:99], v3 offset:12800
    ds_read_b64_tr_b16 v[100:101], v4 offset:12288
    ds_read_b64_tr_b16 v[102:103], v4 offset:12800
    ds_read_b64_tr_b16 v[104:105], v3 offset:14336
    ds_read_b64_tr_b16 v[106:107], v3 offset:14848
    ds_read_b64_tr_b16 v[108:109], v4 offset:14336
    ds_read_b64_tr_b16 v[110:111], v4 offset:14848
    s_add_u32 m0, s30, 8192
    s_and_b32 s47, s46, 0
    s_add_u32 s47, s47, 6
    s_add_u32 s46, s46, 1
    s_mul_i32 s34, s47, 36864
    s_mul_i32 s35, s47, 114688
    buffer_load_dwordx4 v1, s[8:11], s34 offen offset:0 lds
    s_waitcnt lgkmcnt(4)
    v_mfma_f32_32x32x16_bf16 v[16:31], v[96:99], v[160:163], v[16:31]
    s_add_u32 s34, s34, 8192
    buffer_load_dwordx4 v1, s[8:11], s34 offen offset:1024 lds
    v_mfma_f32_32x32x16_bf16 v[32:47], v[96:99], v[164:167], v[32:47]
    s_add_u32 s34, s34, 8192
    buffer_load_dwordx4 v1, s[8:11], s34 offen offset:2048 lds
    v_mfma_f32_32x32x16_bf16 v[48:63], v[100:103], v[160:163], v[48:63]
    s_add_u32 s34, s34, 8192
    buffer_load_dwordx4 v1, s[8:11], s34 offen offset:3072 lds
    v_mfma_f32_32x32x16_bf16 v[64:79], v[100:103], v[164:167], v[64:79]
    s_add_u32 s34, s34, 8192
    buffer_load_dwordx4 v[144:147], v2, s[12:15], s35 offen offset:0
    s_waitcnt lgkmcnt(0)
    v_mfma_f32_32x32x16_bf16 v[16:31], v[104:107], v[168:171], v[16:31]
    buffer_load_dwordx4 v[148:151], v2, s[12:15], s35 offen offset:512
    s_add_u32 s35, s35, 57344
    v_mfma_f32_32x32x16_bf16 v[32:47], v[104:107], v[172:175], v[32:47]
    buffer_load_dwordx4 v[152:155], v2, s[12:15], s35 offen offset:0
    buffer_load_dwordx4 v[156:159], v2, s[12:15], s35 offen offset:512
    v_mfma_f32_32x32x16_bf16 v[48:63], v[108:111], v[168:171], v[48:63]
    s_add_u32 s35, s35, 57344
    v_mfma_f32_32x32x16_bf16 v[64:79], v[108:111], v[172:175], v[64:79]
    s_setprio 2
    s_waitcnt vmcnt(16)
    ds_read_b64_tr_b16 v[80:81], v3 offset:0
    ds_read_b64_tr_b16 v[82:83], v3 offset:512
    ds_read_b64_tr_b16 v[84:85], v4 offset:0
    ds_read_b64_tr_b16 v[86:87], v4 offset:512
    ds_read_b64_tr_b16 v[88:89], v3 offset:2048
    ds_read_b64_tr_b16 v[90:91], v3 offset:2560
    ds_read_b64_tr_b16 v[92:93], v4 offset:2048
    ds_read_b64_tr_b16 v[94:95], v4 offset:2560
    s_add_u32 m0, s30, 12288
    s_and_b32 s47, s46, 0
    s_add_u32 s47, s47, 7
    s_add_u32 s46, s46, 1
    s_mul_i32 s34, s47, 36864
    s_mul_i32 s35, s47, 114688
    buffer_load_dwordx4 v1, s[8:11], s34 offen offset:0 lds
    s_waitcnt lgkmcnt(4)
    v_mfma_f32_32x32x16_bf16 v[16:31], v[80:83], v[112:115], v[16:31]
    s_add_u32 s34, s34, 8192
    buffer_load_dwordx4 v1, s[8:11], s34 offen offset:1024 lds
    v_mfma_f32_32x32x16_bf16 v[32:47], v[80:83], v[116:119], v[32:47]
    s_add_u32 s34, s34, 8192
    buffer_load_dwordx4 v1, s[8:11], s34 offen offset:2048 lds
    v_mfma_f32_32x32x16_bf16 v[48:63], v[84:87], v[112:115], v[48:63]
    s_add_u32 s34, s34, 8192
    buffer_load_dwordx4 v1, s[8:11], s34 offen offset:3072 lds
    v_mfma_f32_32x32x16_bf16 v[64:79], v[84:87], v[116:119], v[64:79]
    s_add_u32 s34, s34, 8192
    buffer_load_dwordx4 v[160:163], v2, s[12:15], s35 offen offset:0
    s_waitcnt lgkmcnt(0)
    v_mfma_f32_32x32x16_bf16 v[16:31], v[88:91], v[120:123], v[16:31]
    buffer_load_dwordx4 v[164:167], v2, s[12:15], s35 offen offset:512
    s_add_u32 s35, s35, 57344
    v_mfma_f32_32x32x16_bf16 v[32:47], v[88:91], v[124:127], v[32:47]
    buffer_load_dwordx4 v[168:171], v2, s[12:15], s35 offen offset:0
    buffer_load_dwordx4 v[172:175], v2, s[12:15], s35 offen offset:512
    v_mfma_f32_32x32x16_bf16 v[48:63], v[92:95], v[120:123], v[48:63]
    s_add_u32 s35, s35, 57344
    v_mfma_f32_32x32x16_bf16 v[64:79], v[92:95], v[124:127], v[64:79]
    s_waitcnt vmcnt(16)
    ds_read_b64_tr_b16 v[96:97], v3 offset:4096
    ds_read_b64_tr_b16 v[98:99], v3 offset:4608
    ds_read_b64_tr_b16 v[100:101], v4 offset:4096
    ds_read_b64_tr_b16 v[102:103], v4 offset:4608
    ds_read_b64_tr_b16 v[104:105], v3 offset:6144
    ds_read_b64_tr_b16 v[106:107], v3 offset:6656
    ds_read_b64_tr_b16 v[108:109], v4 offset:6144
    ds_read_b64_tr_b16 v[110:111], v4 offset:6656
    s_add_u32 m0, s30, 0
    s_and_b32 s47, s46, 0
    s_add_u32 s47, s47, 8
    s_add_u32 s46, s46, 1
    s_mul_i32 s34, s47, 36864
    s_mul_i32 s35, s47, 114688
    buffer_load_dwordx4 v1, s[8:11], s34 offen offset:0 lds
    s_waitcnt lgkmcnt(4)
    v_mfma_f32_32x32x16_bf16 v[16:31], v[96:99], v[128:131], v[16:31]
    s_add_u32 s34, s34, 8192
    buffer_load_dwordx4 v1, s[8:11], s34 offen offset:1024 lds
    v_mfma_f32_32x32x16_bf16 v[32:47], v[96:99], v[132:135], v[32:47]
    s_add_u32 s34, s34, 8192
    buffer_load_dwordx4 v1, s[8:11], s34 offen offset:2048 lds
    v_mfma_f32_32x32x16_bf16 v[48:63], v[100:103], v[128:131], v[48:63]
    s_add_u32 s34, s34, 8192
    buffer_load_dwordx4 v1, s[8:11], s34 offen offset:3072 lds
    v_mfma_f32_32x32x16_bf16 v[64:79], v[100:103], v[132:135], v[64:79]
    s_add_u32 s34, s34, 8192
    buffer_load_dwordx4 v[112:115], v2, s[12:15], s35 offen offset:0
    s_waitcnt lgkmcnt(0)
    v_mfma_f32_32x32x16_bf16 v[16:31], v[104:107], v[136:139], v[16:31]
    buffer_load_dwordx4 v[116:119], v2, s[12:15], s35 offen offset:512
    s_add_u32 s35, s35, 57344
    v_mfma_f32_32x32x16_bf16 v[32:47], v[104:107], v[140:143], v[32:47]
    buffer_load_dwordx4 v[120:123], v2, s[12:15], s35 offen offset:0
    buffer_load_dwordx4 v[124:127], v2, s[12:15], s35 offen offset:512
    v_mfma_f32_32x32x16_bf16 v[48:63], v[108:111], v[136:139], v[48:63]
    s_add_u32 s35, s35, 57344
    v_mfma_f32_32x32x16_bf16 v[64:79], v[108:111], v[140:143], v[64:79]
    s_waitcnt vmcnt(16)
    ds_read_b64_tr_b16 v[80:81], v3 offset:8192
    ds_read_b64_tr_b16 v[82:83], v3 offset:8704
    ds_read_b64_tr_b16 v[84:85], v4 offset:8192
    ds_read_b64_tr_b16 v[86:87], v4 offset:8704
    ds_read_b64_tr_b16 v[88:89], v3 offset:10240
    ds_read_b64_tr_b16 v[90:91], v3 offset:10752
    ds_read_b64_tr_b16 v[92:93], v4 offset:10240
    ds_read_b64_tr_b16 v[94:95], v4 offset:10752
    s_add_u32 m0, s30, 4096
    s_and_b32 s47, s46, 0
    s_add_u32 s47, s47, 9
    s_add_u32 s46, s46, 1
    s_mul_i32 s34, s47, 36864
    s_mul_i32 s35, s47, 114688
    buffer_load_dwordx4 v1, s[8:11], s34 offen offset:0 lds
    s_waitcnt lgkmcnt(4)
    v_mfma_f32_32x32x16_bf16 v[16:31], v[80:83], v[144:147], v[16:31]
    s_add_u32 s34, s34, 8192
    buffer_load_dwordx4 v1, s[8:11], s34 offen offset:1024 lds
    v_mfma_f32_32x32x16_bf16 v[32:47], v[80:83], v[148:151], v[32:47]
    s_add_u32 s34, s34, 8192
    buffer_load_dwordx4 v1, s[8:11], s34 offen offset:2048 lds
    v_mfma_f32_32x32x16_bf16 v[48:63], v[84:87], v[144:147], v[48:63]
    s_add_u32 s34, s34, 8192
    buffer_load_dwordx4 v1, s[8:11], s34 offen offset:3072 lds
    v_mfma_f32_32x32x16_bf16 v[64:79], v[84:87], v[148:151], v[64:79]
    s_add_u32 s34, s34, 8192
    buffer_load_dwordx4 v[128:131], v2, s[12:15], s35 offen offset:0
    s_waitcnt lgkmcnt(0)
    v_mfma_f32_32x32x16_bf16 v[16:31], v[88:91], v[152:155], v[16:31]
    buffer_load_dwordx4 v[132:135], v2, s[12:15], s35 offen offset:512
    s_add_u32 s35, s35, 57344
    v_mfma_f32_32x32x16_bf16 v[32:47], v[88:91], v[156:159], v[32:47]
    buffer_load_dwordx4 v[136:139], v2, s[12:15], s35 offen offset:0
    buffer_load_dwordx4 v[140:143], v2, s[12:15], s35 offen offset:512
    v_mfma_f32_32x32x16_bf16 v[48:63], v[92:95], v[152:155], v[48:63]
    s_add_u32 s35, s35, 57344
    v_mfma_f32_32x32x16_bf16 v[64:79], v[92:95], v[156:159], v[64:79]
    s_waitcnt vmcnt(16)
    ds_read_b64_tr_b16 v[96:97], v3 offset:12288
    ds_read_b64_tr_b16 v[98:99], v3 offset:12800
    ds_read_b64_tr_b16 v[100:101], v4 offset:12288
    ds_read_b64_tr_b16 v[102:103], v4 offset:12800
    ds_read_b64_tr_b16 v[104:105], v3 offset:14336
    ds_read_b64_tr_b16 v[106:107], v3 offset:14848
    ds_read_b64_tr_b16 v[108:109], v4 offset:14336
    ds_read_b64_tr_b16 v[110:111], v4 offset:14848
    s_add_u32 m0, s30, 8192
    s_and_b32 s47, s46, 0
    s_add_u32 s47, s47, 10
    s_add_u32 s46, s46, 1
    s_mul_i32 s34, s47, 36864
    s_mul_i32 s35, s47, 114688
    buffer_load_dwordx4 v1, s[8:11], s34 offen offset:0 lds
    s_waitcnt lgkmcnt(4)
    v_mfma_f32_32x32x16_bf16 v[16:31], v[96:99], v[160:163], v[16:31]
    s_add_u32 s34, s34, 8192
    buffer_load_dwordx4 v1, s[8:11], s34 offen offset:1024 lds
    v_mfma_f32_32x32x16_bf16 v[32:47], v[96:99], v[164:167], v[32:47]
    s_add_u32 s34, s34, 8192
    buffer_load_dwordx4 v1, s[8:11], s34 offen offset:2048 lds
    v_mfma_f32_32x32x16_bf16 v[48:63], v[100:103], v[160:163], v[48:63]
    s_add_u32 s34, s34, 8192
    buffer_load_dwordx4 v1, s[8:11], s34 offen offset:3072 lds
    v_mfma_f32_32x32x16_bf16 v[64:79], v[100:103], v[164:167], v[64:79]
    s_add_u32 s34, s34, 8192
    buffer_load_dwordx4 v[144:147], v2, s[12:15], s35 offen offset:0
    s_waitcnt lgkmcnt(0)
    v_mfma_f32_32x32x16_bf16 v[16:31], v[104:107], v[168:171], v[16:31]
    buffer_load_dwordx4 v[148:151], v2, s[12:15], s35 offen offset:512
    s_add_u32 s35, s35, 57344
    v_mfma_f32_32x32x16_bf16 v[32:47], v[104:107], v[172:175], v[32:47]
    buffer_load_dwordx4 v[152:155], v2, s[12:15], s35 offen offset:0
    buffer_load_dwordx4 v[156:159], v2, s[12:15], s35 offen offset:512
    v_mfma_f32_32x32x16_bf16 v[48:63], v[108:111], v[168:171], v[48:63]
    s_add_u32 s35, s35, 57344
    v_mfma_f32_32x32x16_bf16 v[64:79], v[108:111], v[172:175], v[64:79]
    s_setprio 1
    s_waitcnt vmcnt(16)
    ds_read_b64_tr_b16 v[80:81], v3 offset:0
    ds_read_b64_tr_b16 v[82:83], v3 offset:512
    ds_read_b64_tr_b16 v[84:85], v4 offset:0
    ds_read_b64_tr_b16 v[86:87], v4 offset:512
    ds_read_b64_tr_b16 v[88:89], v3 offset:2048
    ds_read_b64_tr_b16 v[90:91], v3 offset:2560
    ds_read_b64_tr_b16 v[92:93], v4 offset:2048
    ds_read_b64_tr_b16 v[94:95], v4 offset:2560
    s_add_u32 m0, s30, 12288
    s_and_b32 s47, s46, 0
    s_add_u32 s47, s47, 11
    s_add_u32 s46, s46, 1
    s_mul_i32 s34, s47, 36864
    s_mul_i32 s35, s47, 114688
    buffer_load_dwordx4 v1, s[8:11], s34 offen offset:0 lds
    s_waitcnt lgkmcnt(4)
    v_mfma_f32_32x32x16_bf16 v[16:31], v[80:83], v[112:115], v[16:31]
    s_add_u32 s34, s34, 8192
    buffer_load_dwordx4 v1, s[8:11], s34 offen offset:1024 lds
    v_mfma_f32_32x32x16_bf16 v[32:47], v[80:83], v[116:119], v[32:47]
    s_add_u32 s34, s34, 8192
    buffer_load_dwordx4 v1, s[8:11], s34 offen offset:2048 lds
    v_mfma_f32_32x32x16_bf16 v[48:63], v[84:87], v[112:115], v[48:63]
    s_add_u32 s34, s34, 8192
    buffer_load_dwordx4 v1, s[8:11], s34 offen offset:3072 lds
    v_mfma_f32_32x32x16_bf16 v[64:79], v[84:87], v[116:119], v[64:79]
    s_add_u32 s34, s34, 8192
    buffer_load_dwordx4 v[160:163], v2, s[12:15], s35 offen offset:0
    s_waitcnt lgkmcnt(0)
    v_mfma_f32_32x32x16_bf16 v[16:31], v[88:91], v[120:123], v[16:31]
    buffer_load_dwordx4 v[164:167], v2, s[12:15], s35 offen offset:512
    s_add_u32 s35, s35, 57344
    v_mfma_f32_32x32x16_bf16 v[32:47], v[88:91], v[124:127], v[32:47]
    buffer_load_dwordx4 v[168:171], v2, s[12:15], s35 offen offset:0
    buffer_load_dwordx4 v[172:175], v2, s[12:15], s35 offen offset:512
    v_mfma_f32_32x32x16_bf16 v[48:63], v[92:95], v[120:123], v[48:63]
    s_add_u32 s35, s35, 57344
    v_mfma_f32_32x32x16_bf16 v[64:79], v[92:95], v[124:127], v[64:79]
    s_waitcnt vmcnt(16)
    ds_read_b64_tr_b16 v[96:97], v3 offset:4096
    ds_read_b64_tr_b16 v[98:99], v3 offset:4608
    ds_read_b64_tr_b16 v[100:101], v4 offset:4096
    ds_read_b64_tr_b16 v[102:103], v4 offset:4608
    ds_read_b64_tr_b16 v[104:105], v3 offset:6144
    ds_read_b64_tr_b16 v[106:107], v3 offset:6656
    ds_read_b64_tr_b16 v[108:109], v4 offset:6144
    ds_read_b64_tr_b16 v[110:111], v4 offset:6656
    s_add_u32 m0, s30, 0
    s_and_b32 s47, s46, 0
    s_add_u32 s47, s47, 12
    s_add_u32 s46, s46, 1
    s_mul_i32 s34, s47, 36864
    s_mul_i32 s35, s47, 114688
    buffer_load_dwordx4 v1, s[8:11], s34 offen offset:0 lds
    s_waitcnt lgkmcnt(4)
    v_mfma_f32_32x32x16_bf16 v[16:31], v[96:99], v[128:131], v[16:31]
    s_add_u32 s34, s34, 8192
    buffer_load_dwordx4 v1, s[8:11], s34 offen offset:1024 lds
    v_mfma_f32_32x32x16_bf16 v[32:47], v[96:99], v[132:135], v[32:47]
    s_add_u32 s34, s34, 8192
    buffer_load_dwordx4 v1, s[8:11], s34 offen offset:2048 lds
    v_mfma_f32_32x32x16_bf16 v[48:63], v[100:103], v[128:131], v[48:63]
    s_add_u32 s34, s34, 8192
    buffer_load_dwordx4 v1, s[8:11], s34 offen offset:3072 lds
    v_mfma_f32_32x32x16_bf16 v[64:79], v[100:103], v[132:135], v[64:79]
    s_add_u32 s34, s34, 8192
    buffer_load_dwordx4 v[112:115], v2, s[12:15], s35 offen offset:0
    s_waitcnt lgkmcnt(0)
    v_mfma_f32_32x32x16_bf16 v[16:31], v[104:107], v[136:139], v[16:31]
    buffer_load_dwordx4 v[116:119], v2, s[12:15], s35 offen offset:512
    s_add_u32 s35, s35, 57344
    v_mfma_f32_32x32x16_bf16 v[32:47], v[104:107], v[140:143], v[32:47]
    buffer_load_dwordx4 v[120:123], v2, s[12:15], s35 offen offset:0
    buffer_load_dwordx4 v[124:127], v2, s[12:15], s35 offen offset:512
    v_mfma_f32_32x32x16_bf16 v[48:63], v[108:111], v[136:139], v[48:63]
    s_add_u32 s35, s35, 57344
    v_mfma_f32_32x32x16_bf16 v[64:79], v[108:111], v[140:143], v[64:79]
    s_waitcnt vmcnt(16)
    ds_read_b64_tr_b16 v[80:81], v3 offset:8192
    ds_read_b64_tr_b16 v[82:83], v3 offset:8704
    ds_read_b64_tr_b16 v[84:85], v4 offset:8192
    ds_read_b64_tr_b16 v[86:87], v4 offset:8704
    ds_read_b64_tr_b16 v[88:89], v3 offset:10240
    ds_read_b64_tr_b16 v[90:91], v3 offset:10752
    ds_read_b64_tr_b16 v[92:93], v4 offset:10240
    ds_read_b64_tr_b16 v[94:95], v4 offset:10752
    s_add_u32 m0, s30, 4096
    s_and_b32 s47, s46, 0
    s_add_u32 s47, s47, 13
    s_add_u32 s46, s46, 1
    s_mul_i32 s34, s47, 36864
    s_mul_i32 s35, s47, 114688
    buffer_load_dwordx4 v1, s[8:11], s34 offen offset:0 lds
    s_waitcnt lgkmcnt(4)
    v_mfma_f32_32x32x16_bf16 v[16:31], v[80:83], v[144:147], v[16:31]
    s_add_u32 s34, s34, 8192
    buffer_load_dwordx4 v1, s[8:11], s34 offen offset:1024 lds
    v_mfma_f32_32x32x16_bf16 v[32:47], v[80:83], v[148:151], v[32:47]
    s_add_u32 s34, s34, 8192
    buffer_load_dwordx4 v1, s[8:11], s34 offen offset:2048 lds
    v_mfma_f32_32x32x16_bf16 v[48:63], v[84:87], v[144:147], v[48:63]
    s_add_u32 s34, s34, 8192
    buffer_load_dwordx4 v1, s[8:11], s34 offen offset:3072 lds
    v_mfma_f32_32x32x16_bf16 v[64:79], v[84:87], v[148:151], v[64:79]
    s_add_u32 s34, s34, 8192
    buffer_load_dwordx4 v[128:131], v2, s[12:15], s35 offen offset:0
    s_waitcnt lgkmcnt(0)
    v_mfma_f32_32x32x16_bf16 v[16:31], v[88:91], v[152:155], v[16:31]
    buffer_load_dwordx4 v[132:135], v2, s[12:15], s35 offen offset:512
    s_add_u32 s35, s35, 57344
    v_mfma_f32_32x32x16_bf16 v[32:47], v[88:91], v[156:159], v[32:47]
    buffer_load_dwordx4 v[136:139], v2, s[12:15], s35 offen offset:0
    buffer_load_dwordx4 v[140:143], v2, s[12:15], s35 offen offset:512
    v_mfma_f32_32x32x16_bf16 v[48:63], v[92:95], v[152:155], v[48:63]
    s_add_u32 s35, s35, 57344
    v_mfma_f32_32x32x16_bf16 v[64:79], v[92:95], v[156:159], v[64:79]
    s_waitcnt vmcnt(16)
    ds_read_b64_tr_b16 v[96:97], v3 offset:12288
    ds_read_b64_tr_b16 v[98:99], v3 offset:12800
    ds_read_b64_tr_b16 v[100:101], v4 offset:12288
    ds_read_b64_tr_b16 v[102:103], v4 offset:12800
    ds_read_b64_tr_b16 v[104:105], v3 offset:14336
    ds_read_b64_tr_b16 v[106:107], v3 offset:14848
    ds_read_b64_tr_b16 v[108:109], v4 offset:14336
    ds_read_b64_tr_b16 v[110:111], v4 offset:14848
    s_add_u32 m0, s30, 8192
    s_and_b32 s47, s46, 0
    s_add_u32 s47, s47, 14
    s_add_u32 s46, s46, 1
    s_mul_i32 s34, s47, 36864
    s_mul_i32 s35, s47, 114688
    buffer_load_dwordx4 v1, s[8:11], s34 offen offset:0 lds
    s_waitcnt lgkmcnt(4)
    v_mfma_f32_32x32x16_bf16 v[16:31], v[96:99], v[160:163], v[16:31]
    s_add_u32 s34, s34, 8192
    buffer_load_dwordx4 v1, s[8:11], s34 offen offset:1024 lds
    v_mfma_f32_32x32x16_bf16 v[32:47], v[96:99], v[164:167], v[32:47]
    s_add_u32 s34, s34, 8192
    buffer_load_dwordx4 v1, s[8:11], s34 offen offset:2048 lds
    v_mfma_f32_32x32x16_bf16 v[48:63], v[100:103], v[160:163], v[48:63]
    s_add_u32 s34, s34, 8192
    buffer_load_dwordx4 v1, s[8:11], s34 offen offset:3072 lds
    v_mfma_f32_32x32x16_bf16 v[64:79], v[100:103], v[164:167], v[64:79]
    s_add_u32 s34, s34, 8192
    buffer_load_dwordx4 v[144:147], v2, s[12:15], s35 offen offset:0
    s_waitcnt lgkmcnt(0)
    v_mfma_f32_32x32x16_bf16 v[16:31], v[104:107], v[168:171], v[16:31]
    buffer_load_dwordx4 v[148:151], v2, s[12:15], s35 offen offset:512
    s_add_u32 s35, s35, 57344
    v_mfma_f32_32x32x16_bf16 v[32:47], v[104:107], v[172:175], v[32:47]
    buffer_load_dwordx4 v[152:155], v2, s[12:15], s35 offen offset:0
    buffer_load_dwordx4 v[156:159], v2, s[12:15], s35 offen offset:512
    v_mfma_f32_32x32x16_bf16 v[48:63], v[108:111], v[168:171], v[48:63]
    s_add_u32 s35, s35, 57344
    v_mfma_f32_32x32x16_bf16 v[64:79], v[108:111], v[172:175], v[64:79]
    s_setprio 0
    s_waitcnt vmcnt(16)
    ds_read_b64_tr_b16 v[80:81], v3 offset:0
    ds_read_b64_tr_b16 v[82:83], v3 offset:512
    ds_read_b64_tr_b16 v[84:85], v4 offset:0
    ds_read_b64_tr_b16 v[86:87], v4 offset:512
    ds_read_b64_tr_b16 v[88:89], v3 offset:2048
    ds_read_b64_tr_b16 v[90:91], v3 offset:2560
    ds_read_b64_tr_b16 v[92:93], v4 offset:2048
    ds_read_b64_tr_b16 v[94:95], v4 offset:2560
    s_add_u32 m0, s30, 12288
    s_and_b32 s47, s46, 0
    s_add_u32 s47, s47, 15
    s_add_u32 s46, s46, 1
    s_mul_i32 s34, s47, 36864
    s_mul_i32 s35, s47, 114688
    buffer_load_dwordx4 v1, s[8:11], s34 offen offset:0 lds
    s_waitcnt lgkmcnt(4)
    v_mfma_f32_32x32x16_bf16 v[16:31], v[80:83], v[112:115], v[16:31]
    s_add_u32 s34, s34, 8192
    buffer_load_dwordx4 v1, s[8:11], s34 offen offset:1024 lds
    v_mfma_f32_32x32x16_bf16 v[32:47], v[80:83], v[116:119], v[32:47]
    s_add_u32 s34, s34, 8192
    buffer_load_dwordx4 v1, s[8:11], s34 offen offset:2048 lds
    v_mfma_f32_32x32x16_bf16 v[48:63], v[84:87], v[112:115], v[48:63]
    s_add_u32 s34, s34, 8192
    buffer_load_dwordx4 v1, s[8:11], s34 offen offset:3072 lds
    v_mfma_f32_32x32x16_bf16 v[64:79], v[84:87], v[116:119], v[64:79]
    s_add_u32 s34, s34, 8192
    buffer_load_dwordx4 v[160:163], v2, s[12:15], s35 offen offset:0
    s_waitcnt lgkmcnt(0)
    v_mfma_f32_32x32x16_bf16 v[16:31], v[88:91], v[120:123], v[16:31]
    buffer_load_dwordx4 v[164:167], v2, s[12:15], s35 offen offset:512
    s_add_u32 s35, s35, 57344
    v_mfma_f32_32x32x16_bf16 v[32:47], v[88:91], v[124:127], v[32:47]
    buffer_load_dwordx4 v[168:171], v2, s[12:15], s35 offen offset:0
    buffer_load_dwordx4 v[172:175], v2, s[12:15], s35 offen offset:512
    v_mfma_f32_32x32x16_bf16 v[48:63], v[92:95], v[120:123], v[48:63]
    s_add_u32 s35, s35, 57344
    v_mfma_f32_32x32x16_bf16 v[64:79], v[92:95], v[124:127], v[64:79]
    s_waitcnt vmcnt(16)
    ds_read_b64_tr_b16 v[96:97], v3 offset:4096
    ds_read_b64_tr_b16 v[98:99], v3 offset:4608
    ds_read_b64_tr_b16 v[100:101], v4 offset:4096
    ds_read_b64_tr_b16 v[102:103], v4 offset:4608
    ds_read_b64_tr_b16 v[104:105], v3 offset:6144
    ds_read_b64_tr_b16 v[106:107], v3 offset:6656
    ds_read_b64_tr_b16 v[108:109], v4 offset:6144
    ds_read_b64_tr_b16 v[110:111], v4 offset:6656
    s_waitcnt lgkmcnt(4)
    v_mfma_f32_32x32x16_bf16 v[16:31], v[96:99], v[128:131], v[16:31]
    v_mfma_f32_32x32x16_bf16 v[32:47], v[96:99], v[132:135], v[32:47]
    v_mfma_f32_32x32x16_bf16 v[48:63], v[100:103], v[128:131], v[48:63]
    v_mfma_f32_32x32x16_bf16 v[64:79], v[100:103], v[132:135], v[64:79]
    s_waitcnt lgkmcnt(0)
    v_mfma_f32_32x32x16_bf16 v[16:31], v[104:107], v[136:139], v[16:31]
    v_mfma_f32_32x32x16_bf16 v[32:47], v[104:107], v[140:143], v[32:47]
    v_mfma_f32_32x32x16_bf16 v[48:63], v[108:111], v[136:139], v[48:63]
    v_mfma_f32_32x32x16_bf16 v[64:79], v[108:111], v[140:143], v[64:79]
    s_waitcnt vmcnt(8)
    ds_read_b64_tr_b16 v[80:81], v3 offset:8192
    ds_read_b64_tr_b16 v[82:83], v3 offset:8704
    ds_read_b64_tr_b16 v[84:85], v4 offset:8192
    ds_read_b64_tr_b16 v[86:87], v4 offset:8704
    ds_read_b64_tr_b16 v[88:89], v3 offset:10240
    ds_read_b64_tr_b16 v[90:91], v3 offset:10752
    ds_read_b64_tr_b16 v[92:93], v4 offset:10240
    ds_read_b64_tr_b16 v[94:95], v4 offset:10752
    s_waitcnt lgkmcnt(4)
    v_mfma_f32_32x32x16_bf16 v[16:31], v[80:83], v[144:147], v[16:31]
    v_mfma_f32_32x32x16_bf16 v[32:47], v[80:83], v[148:151], v[32:47]
    v_mfma_f32_32x32x16_bf16 v[48:63], v[84:87], v[144:147], v[48:63]
    v_mfma_f32_32x32x16_bf16 v[64:79], v[84:87], v[148:151], v[64:79]
    s_waitcnt lgkmcnt(0)
    v_mfma_f32_32x32x16_bf16 v[16:31], v[88:91], v[152:155], v[16:31]
    v_mfma_f32_32x32x16_bf16 v[32:47], v[88:91], v[156:159], v[32:47]
    v_mfma_f32_32x32x16_bf16 v[48:63], v[92:95], v[152:155], v[48:63]
    v_mfma_f32_32x32x16_bf16 v[64:79], v[92:95], v[156:159], v[64:79]
    s_waitcnt vmcnt(0)
    ds_read_b64_tr_b16 v[96:97], v3 offset:12288
    ds_read_b64_tr_b16 v[98:99], v3 offset:12800
    ds_read_b64_tr_b16 v[100:101], v4 offset:12288
    ds_read_b64_tr_b16 v[102:103], v4 offset:12800
    ds_read_b64_tr_b16 v[104:105], v3 offset:14336
    ds_read_b64_tr_b16 v[106:107], v3 offset:14848
    ds_read_b64_tr_b16 v[108:109], v4 offset:14336
    ds_read_b64_tr_b16 v[110:111], v4 offset:14848
    s_waitcnt lgkmcnt(4)
    v_mfma_f32_32x32x16_bf16 v[16:31], v[96:99], v[160:163], v[16:31]
    v_mfma_f32_32x32x16_bf16 v[32:47], v[96:99], v[164:167], v[32:47]
    v_mfma_f32_32x32x16_bf16 v[48:63], v[100:103], v[160:163], v[48:63]
    v_mfma_f32_32x32x16_bf16 v[64:79], v[100:103], v[164:167], v[64:79]
    s_waitcnt lgkmcnt(0)
    v_mfma_f32_32x32x16_bf16 v[16:31], v[104:107], v[168:171], v[16:31]
    v_mfma_f32_32x32x16_bf16 v[32:47], v[104:107], v[172:175], v[32:47]
    v_mfma_f32_32x32x16_bf16 v[48:63], v[108:111], v[168:171], v[48:63]
    v_mfma_f32_32x32x16_bf16 v[64:79], v[108:111], v[172:175], v[64:79]
    v_add_u32 v7, s30, v5
    s_lshl_b32 s34, s7, 11
    v_add_u32 v5, s34, v5
    v_add_u32 v8, 0x10000, v5
    s_nop 7
    ds_write_b128 v7, v[16:19] offset:0
    ds_write_b128 v7, v[20:23] offset:1024
    ds_write_b128 v7, v[24:27] offset:2048
    ds_write_b128 v7, v[28:31] offset:3072
    ds_write_b128 v7, v[32:35] offset:4096
    ds_write_b128 v7, v[36:39] offset:5120
    ds_write_b128 v7, v[40:43] offset:6144
    ds_write_b128 v7, v[44:47] offset:7168
    ds_write_b128 v7, v[48:51] offset:8192
    ds_write_b128 v7, v[52:55] offset:9216
    ds_write_b128 v7, v[56:59] offset:10240
    ds_write_b128 v7, v[60:63] offset:11264
    ds_write_b128 v7, v[64:67] offset:12288
    ds_write_b128 v7, v[68:71] offset:13312
    ds_write_b128 v7, v[72:75] offset:14336
    ds_write_b128 v7, v[76:79] offset:15360
    s_waitcnt lgkmcnt(0)
    s_barrier
    ds_read_b128 v[16:19], v5 offset:0
    ds_read_b128 v[20:23], v5 offset:1024
    ds_read_b128 v[24:27], v5 offset:16384
    ds_read_b128 v[28:31], v5 offset:17408
    ds_read_b128 v[32:35], v5 offset:32768
    ds_read_b128 v[36:39], v5 offset:33792
    ds_read_b128 v[40:43], v5 offset:49152
    ds_read_b128 v[44:47], v5 offset:50176
    ds_read_b128 v[48:51], v8 offset:0
    ds_read_b128 v[52:55], v8 offset:1024
    ds_read_b128 v[56:59], v8 offset:16384
    ds_read_b128 v[60:63], v8 offset:17408
    ds_read_b128 v[64:67], v8 offset:32768
    ds_read_b128 v[68:71], v8 offset:33792
    ds_read_b128 v[72:75], v8 offset:49152
    ds_read_b128 v[76:79], v8 offset:50176
    s_waitcnt lgkmcnt(12)
    v_add_f32 v16, v16, v24
    v_add_f32 v17, v17, v25
    v_add_f32 v18, v18, v26
    v_add_f32 v19, v19, v27
    v_add_f32 v20, v20, v28
    v_add_f32 v21, v21, v29
    v_add_f32 v22, v22, v30
    v_add_f32 v23, v23, v31
    s_waitcnt lgkmcnt(10)
    v_add_f32 v16, v16, v32
    v_add_f32 v17, v17, v33
    v_add_f32 v18, v18, v34
    v_add_f32 v19, v19, v35
    v_add_f32 v20, v20, v36
    v_add_f32 v21, v21, v37
    v_add_f32 v22, v22, v38
    v_add_f32 v23, v23, v39
    s_waitcnt lgkmcnt(8)
    v_add_f32 v16, v16, v40
    v_add_f32 v17, v17, v41
    v_add_f32 v18, v18, v42
    v_add_f32 v19, v19, v43
    v_add_f32 v20, v20, v44
    v_add_f32 v21, v21, v45
    v_add_f32 v22, v22, v46
    v_add_f32 v23, v23, v47
    s_waitcnt lgkmcnt(6)
    v_add_f32 v16, v16, v48
    v_add_f32 v17, v17, v49
    v_add_f32 v18, v18, v50
    v_add_f32 v19, v19, v51
    v_add_f32 v20, v20, v52
    v_add_f32 v21, v21, v53
    v_add_f32 v22, v22, v54
    v_add_f32 v23, v23, v55
    s_waitcnt lgkmcnt(4)
    v_add_f32 v16, v16, v56
    v_add_f32 v17, v17, v57
    v_add_f32 v18, v18, v58
    v_add_f32 v19, v19, v59
    v_add_f32 v20, v20, v60
    v_add_f32 v21, v21, v61
    v_add_f32 v22, v22, v62
    v_add_f32 v23, v23, v63
    s_waitcnt lgkmcnt(2)
    v_add_f32 v16, v16, v64
    v_add_f32 v17, v17, v65
    v_add_f32 v18, v18, v66
    v_add_f32 v19, v19, v67
    v_add_f32 v20, v20, v68
    v_add_f32 v21, v21, v69
    v_add_f32 v22, v22, v70
    v_add_f32 v23, v23, v71
    s_waitcnt lgkmcnt(0)
    v_add_f32 v16, v16, v72
    v_add_f32 v17, v17, v73
    v_add_f32 v18, v18, v74
    v_add_f32 v19, v19, v75
    v_add_f32 v20, v20, v76
    v_add_f32 v21, v21, v77
    v_add_f32 v22, v22, v78
    v_add_f32 v23, v23, v79
    v_cvt_pk_bf16_f32 v80, v16, v17
    v_cvt_pk_bf16_f32 v81, v18, v19
    v_cvt_pk_bf16_f32 v82, v20, v21
    v_cvt_pk_bf16_f32 v83, v22, v23
    buffer_store_dwordx4 v[80:83], v6, s[16:19], 0 offen nt
K2_END:
    s_endpgm
.section .rodata,"a"
.p2align 6
.amdhsa_kernel standalone__mha_block_cached__near_ridge_kernel
  .amdhsa_next_free_vgpr 256
  .amdhsa_next_free_sgpr 96
  .amdhsa_accum_offset 256
  .amdhsa_group_segment_fixed_size 0
  .amdhsa_kernarg_size 64
  .amdhsa_user_sgpr_count 2
  .amdhsa_user_sgpr_kernarg_segment_ptr 1
  .amdhsa_system_sgpr_workgroup_id_x 1
.end_amdhsa_kernel
.section .rodata,"a"
.p2align 6
.amdhsa_kernel oproj_kernel
  .amdhsa_next_free_vgpr 176
  .amdhsa_next_free_sgpr 96
  .amdhsa_accum_offset 176
  .amdhsa_group_segment_fixed_size 0
  .amdhsa_kernarg_size 64
  .amdhsa_user_sgpr_count 2
  .amdhsa_user_sgpr_kernarg_segment_ptr 1
  .amdhsa_system_sgpr_workgroup_id_x 1
.end_amdhsa_kernel
```
